```python
import torch

def _softmax(x, axis=-1):
    return torch.softmax(x, dim=axis)
def _gelu(x):
    return torch.nn.functional.gelu(x, approximate="tanh")
def _silu(x):
    return torch.nn.functional.silu(x)
def _sigmoid(x):
    return torch.sigmoid(x)
def _layernorm(x, axis=-1, eps=1e-5):
    m = x.mean(dim=axis, keepdim=True)
    v = x.var(dim=axis, keepdim=True, unbiased=False)
    return (x - m) / torch.sqrt(v + eps)
def _scatter_add(tgt, idx, src, axis=0):
    return tgt.clone().index_add_(axis, idx, src)
def _segment_sum(src, seg, n):
    out = torch.zeros((n,) + src.shape[1:], dtype=src.dtype)
    return out.index_add_(0, seg, src)
def _pad(x, pw):
    flat = tuple(v for pair in reversed(pw) for v in pair)
    return torch.nn.functional.pad(x, flat)

kernel_name = 'gated_mix__ssm_conv_s4__ssm_conv_h3__prompt'

def setup_inputs():

    _w = (lambda a: (lambda t: t.to(torch.bfloat16) if t.is_floating_point() else t)(torch.as_tensor(a)))
    def _A_setup():
        B, L, D, N = 1, 2048, 448, 256
        A_re = -(lambda _x: torch.exp(torch.as_tensor(_x)))((lambda *s: torch.randn(*s, dtype=torch.bfloat16) * 6.4)(D, N))
        A_im = torch.pi * (lambda *s: torch.randn(*s, dtype=torch.bfloat16) * 0.05)(D, N)
        B_re = (lambda *s: torch.randn(*s, dtype=torch.bfloat16) * 0.1)(D, N)
        B_im = (lambda *s: torch.randn(*s, dtype=torch.bfloat16) * 0.1)(D, N)
        C_re = (lambda *s: torch.randn(*s, dtype=torch.bfloat16) * 0.1)(D, N)
        C_im = (lambda *s: torch.randn(*s, dtype=torch.bfloat16) * 0.1)(D, N)
        log_dt = (lambda *s: torch.randn(*s, dtype=torch.bfloat16) * 0.05)(D) * 0.5 - 4.0
        Dskip = (lambda *s: torch.randn(*s, dtype=torch.bfloat16) * 0.05)(D)
        return {
            "u": _w((lambda *s: torch.randn(*s, dtype=torch.bfloat16) * 0.05)(B, L, D)),
            "A_re": _w(A_re),
            "A_im": _w(A_im),
            "B_re": _w(B_re),
            "B_im": _w(B_im),
            "C_re": _w(C_re),
            "C_im": _w(C_im),
            "log_dt": _w(log_dt),
            "Dskip": _w(Dskip),
        }
    _A_in = _A_setup()

    def _B_setup():
        B, S, D = 1, 2048, 448
        ks = 4
        return {
            "q": _w((lambda *s: torch.randn(*s, dtype=torch.bfloat16) * 0.05)(B, S, D)),
            "k": _w((lambda *s: torch.randn(*s, dtype=torch.bfloat16) * 0.4)(B, S, D)),
            "v": _w((lambda *s: torch.randn(*s, dtype=torch.bfloat16) * 0.4)(B, S, D)),
            "shift_k": _w((lambda *s: torch.randn(*s, dtype=torch.bfloat16) * 0.4)(D, ks) * 0.5),
            "ssm_k": _w((lambda *s: torch.randn(*s, dtype=torch.bfloat16) * 0.4)(D, S) * (1.0 / S ** 0.5)),
            "ssm_D": _w((lambda *s: torch.randn(*s, dtype=torch.bfloat16) * 0.4)(D)),
        }
    _B_in = _B_setup()

    return {
        "A_u": _A_in["u"],
        "A_A_re": _A_in["A_re"],
        "A_A_im": _A_in["A_im"],
        "A_B_re": _A_in["B_re"],
        "A_B_im": _A_in["B_im"],
        "A_C_re": _A_in["C_re"],
        "A_C_im": _A_in["C_im"],
        "A_log_dt": _A_in["log_dt"],
        "A_Dskip": _A_in["Dskip"],
        "B_q": _B_in["q"],
        "B_k": _B_in["k"],
        "B_v": _B_in["v"],
        "B_shift_k": _B_in["shift_k"],
        "B_ssm_k": _B_in["ssm_k"],
        "B_ssm_D": _B_in["ssm_D"],
        "gate_w": _w((lambda *s: torch.randn(*s, dtype=torch.bfloat16) * 0.05)(448) * 16.0),
    }

def reference(A_u, A_A_re, A_A_im, A_B_re, A_B_im, A_C_re, A_C_im, A_log_dt, A_Dskip, B_q, B_k, B_v, B_shift_k, B_ssm_k, B_ssm_D, gate_w):
    def _A_ref(u, A_re, A_im, B_re, B_im, C_re, C_im, log_dt, Dskip):
        Bsz, L, D = u.shape
        dt = torch.exp(log_dt)[:, None]
        A = A_re + 1j * A_im
        Bc = B_re + 1j * B_im
        Cc = C_re + 1j * C_im
        logdA = dt * A
        dB = dt * Bc
        l = (lambda x, dt: x.to(dt))(torch.arange(L), A_re.dtype)
        P = torch.exp(logdA[:, :, None] * l[None, None, :])
        K = torch.einsum("dn,dnl,dn->dl", Cc, P, dB).real
        L2 = 2 * L
        Kp = _pad(K, ((0, 0), (0, L)))
        up = (lambda x, *d: x.permute(*d))(u, 0, 2, 1)
        up = _pad(up, ((0, 0), (0, 0), (0, L)))
        Kf = (lambda x, axes=(-2,-1): torch.fft.rfft2(x.float(), dim=axes))(Kp[:, None, :], axes=(-2, -1))
        Uf = (lambda x, axes=(-2,-1): torch.fft.rfft2(x.float(), dim=axes))(up[:, :, None, :], axes=(-2, -1))
        Yf = Uf * Kf[None, :, :, :]
        y = (lambda x, s, axes=(-2,-1): torch.fft.irfft2(x, s=s, dim=axes).to(torch.bfloat16))(Yf, (1, L2), axes=(-2, -1))[:, :, 0, :L]
        y = (lambda x, *d: x.permute(*d))(y, 0, 2, 1) + u * Dskip[None, None, :]
        return y

    def _B_ref(q, k, v, shift_k, ssm_k, ssm_D):
        B, S, D = q.shape
        ks = shift_k.shape[-1]
        k_pad = _pad(k, ((0, 0), (ks - 1, 0), (0, 0)))
        k_shift = torch.zeros_like(k)
        for t in range(ks):
            k_shift = k_shift + k_pad[:, t:t + S, :] * shift_k[:, ks - 1 - t][None, None, :]
        kv = k_shift * v
        L = 2 * S
        kv_pad = _pad(kv, ((0, 0), (0, S), (0, 0)))
        kf_pad = _pad(ssm_k, ((0, 0), (0, S)))
        kv_f = (lambda x, axes=(-2,-1): torch.fft.rfft2(x.float(), dim=axes))(kv_pad[:, None, :, :], axes=(1, 2))
        kf_f = (lambda x, axes=(-2,-1): torch.fft.rfft2(x.float(), dim=axes))(kf_pad[:, None, :], axes=(1, 2))
        kf_f = (lambda x, *d: x.permute(*d))(kf_f, 1, 2, 0)
        y_f = kv_f * kf_f[None, :, :, :]
        y = (lambda x, s, axes=(-2,-1): torch.fft.irfft2(x, s=s, dim=axes).to(torch.bfloat16))(y_f, (1, L), axes=(1, 2))[:, 0, :S, :]
        y = y + kv * ssm_D[None, None, :]
        return q * y

    x = A_u
    g = _sigmoid((x * gate_w).sum(-1, keepdims=True))
    a = _A_ref(x, A_A_re, A_A_im, A_B_re, A_B_im, A_C_re, A_C_im, A_log_dt, A_Dskip)
    b = _B_ref(x, B_k, B_v, B_shift_k, B_ssm_k, B_ssm_D)
    return g * a + (1 - g) * b
```

```asm
; @launch grid=(256,1,1) block=(768,1,1) lds=163840
.amdgcn_target "amdgcn-amd-amdhsa--gfx950"
.text
.globl gated_mix__ssm_conv_s4__ssm_conv_h3__prompt_kernel
.p2align 8
.type gated_mix__ssm_conv_s4__ssm_conv_h3__prompt_kernel,@function
gated_mix__ssm_conv_s4__ssm_conv_h3__prompt_kernel:
    s_cmp_ge_u32 s2, 256
    s_cbranch_scc1 F_exit
    s_load_dwordx4 s[36:39], s[0:1], 128
    s_load_dwordx16 s[4:19], s[0:1], 0
    s_load_dwordx16 s[20:35], s[0:1], 64
    s_load_dwordx2 s[40:41], s[0:1], 144
    v_lshrrev_b32 v1, 6, v0
    s_getreg_b32 s63, hwreg(HW_REG_XCC_ID, 0, 3)
    s_mov_b32 s46, 0xffff0000
    v_readfirstlane_b32 s44, v1
    v_and_b32 v1, 63, v0
    s_cmp_ge_u32 s44, 4
    s_cbranch_scc1 F_k
    v_lshlrev_b32 v2, 2, v1
    s_cmp_lg_u32 s44, 0
    s_cbranch_scc1 L_nocensus
    s_or_b32 s57, s63, 0x80
    v_mov_b32 v4, s2
    v_mov_b32 v3, s57
    s_mov_b64 exec, 1
    s_waitcnt lgkmcnt(0)
    global_store_byte v4, v3, s[38:39]
    s_mov_b64 exec, -1
    global_load_dword v4, v2, s[38:39] sc1
L_nocensus:
    s_cmp_lg_u32 s44, 1
    s_cbranch_scc1 L_noepochload
    s_mov_b32 s59, 8486912
    s_waitcnt lgkmcnt(0)
    s_load_dword s72, s[40:41], s59
L_noepochload:
    s_cmp_lg_u32 s44, 1
    s_cbranch_scc1 B_1_skip
    s_mov_b64 exec, 0
    s_branch I_kpost
B_1:
    s_mov_b64 exec, -1
B_1_skip:
    s_cmp_lg_u32 s44, 2
    s_cbranch_scc1 B_2_skip
    s_mov_b64 exec, 0
    s_branch I_tpost
B_2:
    s_mov_b64 exec, -1
B_2_skip:
    s_cmp_lg_u32 s44, 3
    s_cbranch_scc1 B_3_skip
    s_mov_b64 exec, 0
    s_branch I_conv
B_3:
    s_mov_b64 exec, -1
B_3_skip:
    v_and_b32 v5, 28, v0
    v_add_u32 v5, 163488, v5
    v_mov_b32 v6, 0
    ds_write_b32 v5, v6
    v_mov_b32 v6, 0
    v_mov_b32 v7, 0
    v_mov_b32 v8, 0
    v_mov_b32 v9, 0
    s_mul_i32 s47, s44, 5120
    s_add_u32 s47, s47, 107520
    v_lshl_add_u32 v5, v1, 4, s47
    ds_write_b128 v5, v[6:9]
    v_and_b32 v5, 127, v0
    v_lshlrev_b32 v5, 2, v5
    v_add_u32 v5, 162976, v5
    ds_write_b32 v5, v6
    v_and_b32 v5, 7, v0
    v_lshrrev_b32 v6, 3, v0
    v_mul_u32_u24 v7, 1792, v6
    v_lshl_add_u32 v7, v5, 4, v7
    v_lshlrev_b32 v12, 6, v5
    v_sub_u32 v13, 31, v6
    v_and_b32 v14, 3, v13
    v_lshrrev_b32 v13, 2, v13
    v_xor_b32 v13, v13, v5
    v_lshlrev_b32 v13, 4, v13
    v_lshl_add_u32 v13, v14, 2, v13
    v_lshl_add_u32 v13, v5, 10, v13
    v_lshrrev_b32 v14, 2, v5
    v_lshl_add_u32 v13, v14, 10, v13
    v_add_u32 v8, 103424, v13
    v_xor_b32 v13, s44, v5
    v_lshlrev_b32 v13, 4, v13
    v_lshl_add_u32 v13, v6, 7, v13
    v_xor_b32 v14, 64, v13
    v_add_u32 v9, 103424, v13
    v_add_u32 v10, 108544, v14
    v_lshlrev_b32 v13, 12, v6
    v_lshl_add_u32 v11, v5, 4, v13
    v_and_b32 v5, 255, v0
    v_lshlrev_b32 v5, 4, v5
    v_add_u32 v6, 36880, v5
    s_and_b32 s59, s44, 3
    v_and_b32 v13, 15, v1
    v_lshrrev_b32 v14, 4, v1
    v_lshrrev_b32 v17, 1, v13
    v_and_b32 v18, 1, v13
    v_add_u32 v15, 1, v13
    v_and_b32 v16, 3, v15
    v_sub_u32 v15, v15, v16
    v_lshl_add_u32 v15, v14, 3, v15
    v_lshlrev_b32 v15, 1, v15
    v_mul_u32_u24 v16, 4160, v16
    s_mul_i32 s47, s59, 16640
    s_add_u32 s47, s47, 36864
    v_add3_u32 v19, v15, v16, s47
    s_mul_i32 s47, s59, 5120
    s_add_u32 s47, s47, 103456
    s_mul_i32 s56, s59, 9216
    s_add_u32 s56, s56, 0
    v_lshlrev_b32 v15, 4, v14
    v_lshl_add_u32 v16, v18, 6, v15
    v_lshlrev_b32 v18, 5, v18
    v_sub_u32 v15, v15, v18
    v_add_u32 v15, s47, v15
    v_add_u32 v16, s56, v16
    v_sub_u32 v13, 7, v17
    s_movk_i32 s57, 64
    s_movk_i32 s58, 144
    v_mad_u32_u24 v20, v13, s57, v15
    v_mad_u32_u24 v21, v17, s58, v16
    s_movk_i32 s57, 192
    s_movk_i32 s58, 432
    v_mad_u32_u24 v22, v13, s57, v15
    v_mad_u32_u24 v23, v17, s58, v16
    s_movk_i32 s57, 320
    s_movk_i32 s58, 720
    v_mad_u32_u24 v24, v13, s57, v15
    v_mad_u32_u24 v25, v17, s58, v16
    s_movk_i32 s57, 448
    s_movk_i32 s58, 1008
    v_mad_u32_u24 v26, v13, s57, v15
    v_mad_u32_u24 v27, v17, s58, v16
    s_mul_i32 s47, s59, 3456
    s_sub_u32 s47, 123904, s47
    v_add_u32 v28, s47, v25
    s_mul_i32 s47, s59, 5760
    s_sub_u32 s47, 146944, s47
    v_add_u32 v29, s47, v23
    s_lshl_b32 s47, s59, 6
    s_add_u32 s47, s47, 162976
    v_and_b32 v15, 15, v1
    v_lshl_add_u32 v30, v15, 2, s47
    s_cmp_lg_u32 s44, 0
    s_cbranch_scc1 L_norole
    s_or_b32 s57, s63, 0x80
    v_or_b32 v3, 0, v2
    v_cmp_gt_u32 s[64:65], s2, v3
    v_or_b32 v3, 1, v2
    v_cmp_gt_u32 s[66:67], s2, v3
    v_or_b32 v3, 2, v2
    v_cmp_gt_u32 s[68:69], s2, v3
    v_or_b32 v3, 3, v2
    v_cmp_gt_u32 s[70:71], s2, v3
    s_mov_b32 s73, 0
L_census:
    s_waitcnt vmcnt(0)
    v_and_b32 v4, 0xbfbfbfbf, v4
    v_cmp_eq_u32_sdwa s[48:49], v4, s57 src0_sel:BYTE_0 src1_sel:DWORD
    v_cmp_eq_u32_sdwa s[50:51], v4, s57 src0_sel:BYTE_1 src1_sel:DWORD
    v_cmp_eq_u32_sdwa s[52:53], v4, s57 src0_sel:BYTE_2 src1_sel:DWORD
    v_cmp_eq_u32_sdwa s[54:55], v4, s57 src0_sel:BYTE_3 src1_sel:DWORD
    s_bcnt1_i32_b64 s47, s[48:49]
    s_bcnt1_i32_b64 s56, s[50:51]
    s_add_u32 s47, s47, s56
    s_bcnt1_i32_b64 s56, s[52:53]
    s_add_u32 s47, s47, s56
    s_bcnt1_i32_b64 s56, s[54:55]
    s_add_u32 s47, s47, s56
    s_cmp_eq_u32 s47, 32
    s_cbranch_scc1 L_census_ok
    s_waitcnt lgkmcnt(0)
    global_load_dword v4, v2, s[38:39] sc1
    s_add_u32 s73, s73, 1
    s_cmp_lt_u32 s73, 65536
    s_cbranch_scc1 L_census
L_census_static:
    s_waitcnt vmcnt(0)
    s_and_b32 s47, s2, 7
    s_lshr_b32 s56, s2, 3
    s_lshl_b32 s56, s56, 8
    s_or_b32 s47, s47, s56
    s_or_b32 s47, s47, 0x10000
    s_branch L_census_done
L_census_ok:
    s_mov_b32 s47, 0
    s_and_b64 s[48:49], s[48:49], s[64:65]
    s_bcnt1_i32_b64 s56, s[48:49]
    s_add_u32 s47, s47, s56
    s_and_b64 s[50:51], s[50:51], s[66:67]
    s_bcnt1_i32_b64 s56, s[50:51]
    s_add_u32 s47, s47, s56
    s_and_b64 s[52:53], s[52:53], s[68:69]
    s_bcnt1_i32_b64 s56, s[52:53]
    s_add_u32 s47, s47, s56
    s_and_b64 s[54:55], s[54:55], s[70:71]
    s_bcnt1_i32_b64 s56, s[54:55]
    s_add_u32 s47, s47, s56
    s_lshl_b32 s47, s47, 8
    s_or_b32 s47, s47, s63
L_census_done:
    v_mov_b32 v2, 163520
    v_mov_b32 v3, s47
    ds_write_b32 v2, v3
L_norole:
    s_cmp_lg_u32 s44, 1
    s_cbranch_scc1 L_nononce
    s_waitcnt lgkmcnt(0)
    s_add_u32 s72, s72, 2654435760
    s_and_b32 s72, s72, -16
    v_mov_b32 v2, 163524
    v_mov_b32 v3, s72
    ds_write_b32 v2, v3
L_nononce:
    v_mov_b32 v2, 163520
    s_waitcnt lgkmcnt(0)
    s_barrier
    ds_read_b64 v[2:3], v2
    s_waitcnt lgkmcnt(0)
    v_readfirstlane_b32 s47, v2
    v_readfirstlane_b32 s72, v3
    s_and_b32 s42, s47, 7
    s_bfe_u32 s43, s47, 0x50008
    s_lshr_b32 s22, s47, 16
    s_lshl_b32 s45, s42, 6
    s_lshl_b32 s47, s43, 1
    s_add_u32 s45, s45, s47
    s_cmp_eq_u32 s42, 7
    s_cbranch_scc1 F_gate
    s_branch F_tpost
F_k:
    v_mov_b32 v2, 0
    v_mov_b32 v3, 0
    v_mov_b32 v4, 0
    v_mov_b32 v5, 0
    v_mov_b32 v6, 0
    v_mov_b32 v7, 0
    s_sub_u32 s3, s44, 4
    s_lshr_b32 s3, s3, 2
    v_and_b32 v8, 15, v1
    v_lshrrev_b32 v9, 4, v1
    s_sub_u32 s56, s44, 4
    s_mul_i32 s47, s56, 4608
    s_add_u32 s47, s47, 0
    s_mov_b32 m0, s47
    v_mul_u32_u24 v10, 288, v8
    v_lshl_add_u32 v10, v9, 4, v10
    v_add_u32 v12, s47, v10
    s_mul_i32 s47, s56, 3408
    s_add_u32 s47, s47, 123904
    v_lshrrev_b32 v10, 1, v9
    v_lshlrev_b32 v10, 7, v10
    v_and_b32 v11, 1, v9
    v_lshl_add_u32 v10, v11, 2, v10
    v_lshl_add_u32 v10, v8, 3, v10
    v_lshrrev_b32 v11, 4, v10
    v_lshl_add_u32 v11, v11, 2, v10
    v_lshl_add_u32 v13, v11, 2, s47
    v_cmp_gt_u32 vcc, 2, v9
    v_lshlrev_b32 v10, 1, v8
    v_lshlrev_b32 v11, 2, v8
    v_cndmask_b32 v10, v10, v11, vcc
    v_lshl_add_u32 v10, v9, 6, v10
    v_add_u32 v10, 256, v10
    v_lshrrev_b32 v11, 4, v10
    v_lshl_add_u32 v11, v11, 2, v10
    v_lshl_add_u32 v14, v11, 2, s47
    v_mov_b32 v10, 160
    v_cndmask_b32 v10, v10, 8, vcc
    v_add_u32 v15, v14, v10
    v_min_u32 v10, 9, v8
    v_mul_u32_u24 v10, 80, v10
    v_lshl_add_u32 v10, v9, 4, v10
    s_add_u32 s56, s47, 2560
    v_add_u32 v16, s56, v10
    v_and_b32 v8, 255, v0
    v_lshlrev_b32 v8, 4, v8
    s_mul_i32 s59, s3, 5904
    s_add_u32 s59, s59, 151168
    s_mul_i32 s47, s3, 13632
    s_add_u32 s47, s47, 123904
    s_and_b32 s56, s44, 3
    s_mul_i32 s56, s56, 63
    v_add_u32 v18, s56, v1
    v_lshrrev_b32 v10, 2, v18
    v_add_u32 v10, v18, v10
    v_lshl_add_u32 v10, v10, 4, s47
    v_lshrrev_b32 v11, 1, v18
    v_lshl_add_u32 v11, v18, 2, v11
    v_lshl_add_u32 v11, v11, 3, s59
    s_mul_i32 s47, s3, 16640
    s_add_u32 s47, s47, 36880
    v_add_u32 v9, s47, v8
    s_add_u32 s47, s59, 5760
    v_mov_b32 v17, s47
    v_lshrrev_b32 v27, 1, v8
    v_subrev_u32 v27, 8, v27
    v_cvt_f32_i32 v26, v27
    v_add_f32 v27, 1.0, v26
    v_add_f32 v28, 2.0, v26
    v_add_f32 v29, 2.0, v27
    v_add_f32 v30, 4.0, v26
    v_add_f32 v31, 4.0, v27
    v_add_f32 v32, 4.0, v28
    v_add_f32 v33, 4.0, v29
    v_add_f32 v34, 4.0, v30
    v_add_f32 v35, 4.0, v31
    v_add_f32 v36, 4.0, v32
    v_add_f32 v37, 4.0, v33
    v_cvt_pk_bf16_f32 v26, v26, v27
    v_cvt_pk_bf16_f32 v28, v28, v29
    v_cvt_pk_bf16_f32 v30, v30, v31
    v_cvt_pk_bf16_f32 v32, v32, v33
    v_cvt_pk_bf16_f32 v34, v34, v35
    v_cvt_pk_bf16_f32 v36, v36, v37
    v_add_u32_sdwa v26, v26, v26 dst_sel:DWORD dst_unused:UNUSED_PAD src0_sel:WORD_0 src1_sel:WORD_1
    v_add_u32_sdwa v28, v28, v28 dst_sel:DWORD dst_unused:UNUSED_PAD src0_sel:WORD_0 src1_sel:WORD_1
    v_add_u32_sdwa v30, v30, v30 dst_sel:DWORD dst_unused:UNUSED_PAD src0_sel:WORD_0 src1_sel:WORD_1
    v_add_u32_sdwa v32, v32, v32 dst_sel:DWORD dst_unused:UNUSED_PAD src0_sel:WORD_0 src1_sel:WORD_1
    v_add_u32_sdwa v34, v34, v34 dst_sel:DWORD dst_unused:UNUSED_PAD src0_sel:WORD_0 src1_sel:WORD_1
    v_add_u32_sdwa v36, v36, v36 dst_sel:DWORD dst_unused:UNUSED_PAD src0_sel:WORD_0 src1_sel:WORD_1
    v_subrev_u32 v26, 34048, v26
    v_subrev_u32 v28, 34048, v28
    v_subrev_u32 v30, 34048, v30
    v_subrev_u32 v32, 34048, v32
    v_subrev_u32 v34, 34048, v34
    v_subrev_u32 v36, 34048, v36
    s_and_b32 s47, s44, 3
    s_cmp_lg_u32 s47, 0
    s_cbranch_scc1 L_big_k
    v_cmp_gt_u32 vcc, 272, v8
    v_subrev_u32 v27, 15, v8
    v_add_u32 v29, 0, v27
    v_cndmask_b32 v26, v26, v29, vcc
    v_add_u32 v29, 4, v27
    v_cndmask_b32 v28, v28, v29, vcc
    v_add_u32 v29, 8, v27
    v_cndmask_b32 v30, v30, v29, vcc
    v_add_u32 v29, 12, v27
    v_cndmask_b32 v32, v32, v29, vcc
    v_add_u32 v29, 16, v27
    v_cndmask_b32 v34, v34, v29, vcc
    v_add_u32 v29, 20, v27
    v_cndmask_b32 v36, v36, v29, vcc
    v_cmp_eq_u32 vcc, 0, v8
    v_mov_b32 v27, 1296
    s_nop 0
    v_cndmask_b32 v26, v26, v27, vcc
    v_cndmask_b32 v28, v28, v27, vcc
    v_cndmask_b32 v30, v30, v27, vcc
    v_cndmask_b32 v32, v32, v27, vcc
L_big_k:
    v_lshrrev_b32 v27, 4, v26
    v_lshl_add_u32 v26, v27, 1, v26
    v_lshl_add_u32 v20, v26, 2, s59
    v_lshrrev_b32 v29, 4, v28
    v_lshl_add_u32 v28, v29, 1, v28
    v_lshl_add_u32 v21, v28, 2, s59
    v_lshrrev_b32 v31, 4, v30
    v_lshl_add_u32 v30, v31, 1, v30
    v_lshl_add_u32 v22, v30, 2, s59
    v_lshrrev_b32 v33, 4, v32
    v_lshl_add_u32 v32, v33, 1, v32
    v_lshl_add_u32 v23, v32, 2, s59
    v_lshrrev_b32 v35, 4, v34
    v_lshl_add_u32 v34, v35, 1, v34
    v_lshl_add_u32 v24, v34, 2, s59
    v_lshrrev_b32 v37, 4, v36
    v_lshl_add_u32 v36, v37, 1, v36
    v_lshl_add_u32 v25, v36, 2, s59
    s_sub_u32 s56, s44, 4
    v_lshl_add_u32 v26, s56, 6, v1
    v_lshrrev_b32 v19, 3, v26
    v_add_u32 v19, v26, v19
    v_lshlrev_b32 v19, 4, v19
    v_add_u32 v27, 0, v19
    v_lshlrev_b32 v19, 3, v26
    v_sub_u32 v28, 107512, v19
    v_lshlrev_b32 v19, 4, v26
    v_add_u32 v30, 7340032, v19
    v_mul_u32_u24 v29, 3584, v26
    v_and_b32 v19, 7, v1
    v_lshlrev_b32 v19, 6, v19
    v_add_u32 v31, 162976, v19
    v_mov_b32 v32, 163520
    s_waitcnt lgkmcnt(0)
    s_barrier
    ds_read_b64 v[32:33], v32
    s_waitcnt lgkmcnt(0)
    v_readfirstlane_b32 s47, v32
    v_readfirstlane_b32 s72, v33
    s_and_b32 s42, s47, 7
    s_bfe_u32 s43, s47, 0x50008
    s_lshr_b32 s22, s47, 16
    s_lshl_b32 s45, s42, 6
    s_lshl_b32 s47, s43, 1
    s_add_u32 s45, s45, s47
    s_cmp_eq_u32 s42, 7
    s_cbranch_scc1 F_gate
    s_branch F_kpost
F_k_end:
.p2align 12
I_kpost:
    s_cbranch_execz B_1
F_kpost:
    s_setprio 3
    s_lshl_b32 s56, s45, 9
    s_lshl_b32 s57, s44, 7
    s_add_u32 s56, s56, s57
    s_sub_u32 s56, s56, 512
    v_lshl_add_u32 v19, v1, 1, s56
    global_load_short_d16_hi v2, v19, s[6:7] nt
    global_load_short_d16_hi v3, v19, s[8:9] nt
    global_load_short_d16_hi v4, v19, s[10:11] nt
    global_load_short_d16_hi v5, v19, s[12:13] nt
    global_load_short_d16_hi v6, v19, s[14:15] nt
    global_load_short_d16_hi v7, v19, s[16:17] nt
    s_lshl_b32 s58, s45, 1
    s_load_dword s60, s[18:19], s58
    s_load_dword s61, s[20:21], s58
    s_load_dword s62, s[32:33], s58
    s_setprio 0
    v_and_b32 v19, 15, v1
    s_and_b32 s47, s44, 3
    s_lshl_b32 s47, s47, 4
    s_lshl_b32 s56, s42, 6
    s_add_u32 s47, s47, s56
    s_mul_i32 s56, s3, 448
    s_add_u32 s47, s47, s56
    v_add_u32 v19, s47, v19
    v_lshlrev_b32 v19, 12, v19
    s_lshl_b32 s56, s43, 7
    s_sub_u32 s47, 3968, s56
    v_add_u32 v19, s47, v19
    s_waitcnt lgkmcnt(0)
    s_lshl_b32 s47, s60, 16
    s_and_b32 s56, s60, s46
    s_cmp_lt_u32 s44, 8
    s_cselect_b32 s47, s47, s56
    v_mov_b32 v35, 0x3fb8aa3b
    v_mul_f32 v32, s47, v35
    v_fma_f32 v34, s47, v35, -v32
    v_mov_b32 v33, 0x32a57060
    v_fmac_f32 v34, s47, v33
    v_exp_f32 v35, v32
    v_mul_f32 v34, 0x3f317218, v34
    v_fma_f32 v35, v35, v34, v35
    v_cvt_pk_bf16_f32 v32, v35, v35
    v_and_b32 v32, s46, v32
    v_mov_b32 v33, 0x43000000
    s_lshl_b32 s66, s61, 16
    s_and_b32 s67, s61, s46
    s_lshl_b32 s68, s62, 16
    s_and_b32 s69, s62, s46
    s_waitcnt vmcnt(4)
    v_pk_mul_f32 v[2:3], v[2:3], v[32:33] op_sel_hi:[1,0]
    v_mul_f32 v3, 0.15915494, v3
    v_mul_f32 v2, 0x3fb8aa3b, v2
    v_rndne_f32 v121, v3
    v_pk_mul_f32 v[118:119], v[2:3], v[32:33] op_sel:[0,1] op_sel_hi:[1,1]
    v_sub_f32 v121, v3, v121
    v_rndne_f32 v123, v119
    v_exp_f32 v120, v2
    v_cos_f32 v102, v121
    v_sin_f32 v103, v121
    v_sub_f32 v123, v119, v123
    s_waitcnt vmcnt(2)
    v_pk_mul_f32 v[4:5], v[4:5], v[32:33] op_sel_hi:[1,0]
    v_exp_f32 v122, v118
    v_cos_f32 v108, v123
    v_sin_f32 v109, v123
    s_waitcnt vmcnt(0)
    v_pk_mul_f32 v[116:117], v[6:7], v[4:5] op_sel:[0,0] op_sel_hi:[0,1]
    v_pk_fma_f32 v[116:117], v[6:7], v[4:5], v[116:117] op_sel:[1,1,0] op_sel_hi:[1,0,1] neg_lo:[1,0,0]
    v_pk_mul_f32 v[102:103], v[102:103], v[120:121] op_sel_hi:[1,0]
    v_pk_mul_f32 v[132:133], v[116:117], v[102:103] op_sel:[0,0] op_sel_hi:[0,1]
    v_cvt_pk_bf16_f32 v94, v116, -v117
    ds_write_addtid_b32 v94 offset:0
    v_pk_mul_f32 v[108:109], v[108:109], v[122:123] op_sel_hi:[1,0]
    v_pk_fma_f32 v[132:133], v[116:117], v[102:103], v[132:133] op_sel:[1,1,0] op_sel_hi:[1,0,1] neg_lo:[1,0,0]
    v_pk_mul_f32 v[104:105], v[102:103], v[102:103] op_sel:[0,0] op_sel_hi:[0,1]
    v_pk_mul_f32 v[146:147], v[116:117], v[108:109] op_sel:[0,0] op_sel_hi:[0,1]
    v_cvt_pk_bf16_f32 v95, v132, -v133
    ds_write_addtid_b32 v95 offset:288
    v_pk_fma_f32 v[104:105], v[102:103], v[102:103], v[104:105] op_sel:[1,1,0] op_sel_hi:[1,0,1] neg_lo:[1,0,0]
    v_pk_fma_f32 v[146:147], v[116:117], v[108:109], v[146:147] op_sel:[1,1,0] op_sel_hi:[1,0,1] neg_lo:[1,0,0]
    v_pk_mul_f32 v[134:135], v[116:117], v[104:105] op_sel:[0,0] op_sel_hi:[0,1]
    v_cvt_pk_bf16_f32 v96, v146, -v147
    ds_write_addtid_b32 v96 offset:2304
    v_pk_fma_f32 v[134:135], v[116:117], v[104:105], v[134:135] op_sel:[1,1,0] op_sel_hi:[1,0,1] neg_lo:[1,0,0]
    v_pk_mul_f32 v[136:137], v[132:133], v[104:105] op_sel:[0,0] op_sel_hi:[0,1]
    v_cvt_pk_bf16_f32 v97, v134, -v135
    ds_write_addtid_b32 v97 offset:576
    v_pk_fma_f32 v[136:137], v[132:133], v[104:105], v[136:137] op_sel:[1,1,0] op_sel_hi:[1,0,1] neg_lo:[1,0,0]
    v_pk_mul_f32 v[106:107], v[104:105], v[104:105] op_sel:[0,0] op_sel_hi:[0,1]
    v_pk_mul_f32 v[148:149], v[132:133], v[108:109] op_sel:[0,0] op_sel_hi:[0,1]
    v_cvt_pk_bf16_f32 v98, v136, -v137
    ds_write_addtid_b32 v98 offset:864
    v_pk_fma_f32 v[106:107], v[104:105], v[104:105], v[106:107] op_sel:[1,1,0] op_sel_hi:[1,0,1] neg_lo:[1,0,0]
    v_pk_fma_f32 v[148:149], v[132:133], v[108:109], v[148:149] op_sel:[1,1,0] op_sel_hi:[1,0,1] neg_lo:[1,0,0]
    v_pk_mul_f32 v[138:139], v[116:117], v[106:107] op_sel:[0,0] op_sel_hi:[0,1]
    v_cvt_pk_bf16_f32 v99, v148, -v149
    ds_write_addtid_b32 v99 offset:2592
    v_pk_fma_f32 v[138:139], v[116:117], v[106:107], v[138:139] op_sel:[1,1,0] op_sel_hi:[1,0,1] neg_lo:[1,0,0]
    v_pk_mul_f32 v[140:141], v[132:133], v[106:107] op_sel:[0,0] op_sel_hi:[0,1]
    v_cvt_pk_bf16_f32 v100, v138, -v139
    ds_write_addtid_b32 v100 offset:1152
    v_pk_fma_f32 v[140:141], v[132:133], v[106:107], v[140:141] op_sel:[1,1,0] op_sel_hi:[1,0,1] neg_lo:[1,0,0]
    v_pk_mul_f32 v[142:143], v[134:135], v[106:107] op_sel:[0,0] op_sel_hi:[0,1]
    v_cvt_pk_bf16_f32 v101, v140, -v141
    ds_write_addtid_b32 v101 offset:1440
    v_pk_fma_f32 v[142:143], v[134:135], v[106:107], v[142:143] op_sel:[1,1,0] op_sel_hi:[1,0,1] neg_lo:[1,0,0]
    v_pk_mul_f32 v[144:145], v[136:137], v[106:107] op_sel:[0,0] op_sel_hi:[0,1]
    v_cvt_pk_bf16_f32 v94, v142, -v143
    ds_write_addtid_b32 v94 offset:1728
    v_pk_fma_f32 v[144:145], v[136:137], v[106:107], v[144:145] op_sel:[1,1,0] op_sel_hi:[1,0,1] neg_lo:[1,0,0]
    v_pk_mul_f32 v[150:151], v[134:135], v[108:109] op_sel:[0,0] op_sel_hi:[0,1]
    v_cvt_pk_bf16_f32 v95, v144, -v145
    ds_write_addtid_b32 v95 offset:2016
    v_pk_fma_f32 v[150:151], v[134:135], v[108:109], v[150:151] op_sel:[1,1,0] op_sel_hi:[1,0,1] neg_lo:[1,0,0]
    v_pk_mul_f32 v[152:153], v[136:137], v[108:109] op_sel:[0,0] op_sel_hi:[0,1]
    v_cvt_pk_bf16_f32 v96, v150, -v151
    ds_write_addtid_b32 v96 offset:2880
    v_pk_fma_f32 v[152:153], v[136:137], v[108:109], v[152:153] op_sel:[1,1,0] op_sel_hi:[1,0,1] neg_lo:[1,0,0]
    v_pk_mul_f32 v[154:155], v[138:139], v[108:109] op_sel:[0,0] op_sel_hi:[0,1]
    v_cvt_pk_bf16_f32 v97, v152, -v153
    ds_write_addtid_b32 v97 offset:3168
    v_pk_fma_f32 v[154:155], v[138:139], v[108:109], v[154:155] op_sel:[1,1,0] op_sel_hi:[1,0,1] neg_lo:[1,0,0]
    global_load_dword v26, v19, s[40:41] nt
    v_pk_mul_f32 v[156:157], v[140:141], v[108:109] op_sel:[0,0] op_sel_hi:[0,1]
    v_cvt_pk_bf16_f32 v98, v154, -v155
    ds_write_addtid_b32 v98 offset:3456
    v_pk_fma_f32 v[156:157], v[140:141], v[108:109], v[156:157] op_sel:[1,1,0] op_sel_hi:[1,0,1] neg_lo:[1,0,0]
    v_pk_mul_f32 v[158:159], v[142:143], v[108:109] op_sel:[0,0] op_sel_hi:[0,1]
    v_cvt_pk_bf16_f32 v99, v156, -v157
    ds_write_addtid_b32 v99 offset:3744
    v_pk_fma_f32 v[158:159], v[142:143], v[108:109], v[158:159] op_sel:[1,1,0] op_sel_hi:[1,0,1] neg_lo:[1,0,0]
    v_pk_mul_f32 v[160:161], v[144:145], v[108:109] op_sel:[0,0] op_sel_hi:[0,1]
    v_cvt_pk_bf16_f32 v100, v158, -v159
    ds_write_addtid_b32 v100 offset:4032
    v_pk_fma_f32 v[160:161], v[144:145], v[108:109], v[160:161] op_sel:[1,1,0] op_sel_hi:[1,0,1] neg_lo:[1,0,0]
    v_cvt_pk_bf16_f32 v101, v160, -v161
    ds_write_addtid_b32 v101 offset:4320
    ds_read_b128 v[46:49], v12 offset:0
    v_pk_mul_f32 v[124:125], v[106:107], v[106:107] op_sel:[0,0] op_sel_hi:[0,1]
    ds_read_b128 v[50:53], v12 offset:64
    v_pk_fma_f32 v[124:125], v[106:107], v[106:107], v[124:125] op_sel:[1,1,0] op_sel_hi:[1,0,1] neg_lo:[1,0,0]
    v_mov_b32 v94, 0x3f80
    v_pk_mul_f32 v[126:127], v[124:125], v[124:125] op_sel:[0,0] op_sel_hi:[0,1]
    ds_read_b128 v[54:57], v12 offset:128
    v_cvt_pk_bf16_f32 v95, v124, v125
    v_pk_fma_f32 v[126:127], v[124:125], v[124:125], v[126:127] op_sel:[1,1,0] op_sel_hi:[1,0,1] neg_lo:[1,0,0]
    v_pk_mul_f32 v[128:129], v[126:127], v[124:125] op_sel:[0,0] op_sel_hi:[0,1]
    ds_read_b128 v[58:61], v12 offset:192
    v_cvt_pk_bf16_f32 v96, v126, v127
    v_pk_fma_f32 v[128:129], v[126:127], v[124:125], v[128:129] op_sel:[1,1,0] op_sel_hi:[1,0,1] neg_lo:[1,0,0]
    v_pk_mul_f32 v[130:131], v[126:127], v[126:127] op_sel:[0,0] op_sel_hi:[0,1]
    ds_write_addtid_b32 v94 offset:0
    v_cvt_pk_bf16_f32 v97, v128, v129
    ds_write_addtid_b32 v95 offset:288
    v_pk_fma_f32 v[130:131], v[126:127], v[126:127], v[130:131] op_sel:[1,1,0] op_sel_hi:[1,0,1] neg_lo:[1,0,0]
    ds_write_addtid_b32 v96 offset:576
    v_pk_mul_f32 v[162:163], v[130:131], v[124:125] op_sel:[0,0] op_sel_hi:[0,1]
    ds_write_addtid_b32 v97 offset:864
    v_cvt_pk_bf16_f32 v98, v130, v131
    ds_write_addtid_b32 v98 offset:1152
    v_pk_fma_f32 v[162:163], v[130:131], v[124:125], v[162:163] op_sel:[1,1,0] op_sel_hi:[1,0,1] neg_lo:[1,0,0]
    v_pk_mul_f32 v[164:165], v[130:131], v[126:127] op_sel:[0,0] op_sel_hi:[0,1]
    v_cvt_pk_bf16_f32 v99, v162, v163
    ds_write_addtid_b32 v99 offset:1440
    v_pk_fma_f32 v[164:165], v[130:131], v[126:127], v[164:165] op_sel:[1,1,0] op_sel_hi:[1,0,1] neg_lo:[1,0,0]
    v_pk_mul_f32 v[166:167], v[130:131], v[128:129] op_sel:[0,0] op_sel_hi:[0,1]
    v_cvt_pk_bf16_f32 v100, v164, v165
    ds_write_addtid_b32 v100 offset:1728
    v_pk_fma_f32 v[166:167], v[130:131], v[128:129], v[166:167] op_sel:[1,1,0] op_sel_hi:[1,0,1] neg_lo:[1,0,0]
    v_pk_mul_f32 v[2:3], v[130:131], v[130:131] op_sel:[0,0] op_sel_hi:[0,1]
    v_cvt_pk_bf16_f32 v101, v166, v167
    ds_write_addtid_b32 v101 offset:2016
    v_pk_fma_f32 v[2:3], v[130:131], v[130:131], v[2:3] op_sel:[1,1,0] op_sel_hi:[1,0,1] neg_lo:[1,0,0]
    v_pk_mul_f32 v[4:5], v[2:3], v[124:125] op_sel:[0,0] op_sel_hi:[0,1]
    v_cvt_pk_bf16_f32 v94, v2, v3
    ds_write_addtid_b32 v94 offset:2304
    v_pk_fma_f32 v[4:5], v[2:3], v[124:125], v[4:5] op_sel:[1,1,0] op_sel_hi:[1,0,1] neg_lo:[1,0,0]
    v_pk_mul_f32 v[6:7], v[2:3], v[126:127] op_sel:[0,0] op_sel_hi:[0,1]
    v_cvt_pk_bf16_f32 v95, v4, v5
    ds_write_addtid_b32 v95 offset:2592
    v_pk_fma_f32 v[6:7], v[2:3], v[126:127], v[6:7] op_sel:[1,1,0] op_sel_hi:[1,0,1] neg_lo:[1,0,0]
    v_pk_mul_f32 v[102:103], v[2:3], v[128:129] op_sel:[0,0] op_sel_hi:[0,1]
    v_cvt_pk_bf16_f32 v96, v6, v7
    ds_write_addtid_b32 v96 offset:2880
    v_pk_fma_f32 v[102:103], v[2:3], v[128:129], v[102:103] op_sel:[1,1,0] op_sel_hi:[1,0,1] neg_lo:[1,0,0]
    v_pk_mul_f32 v[104:105], v[2:3], v[130:131] op_sel:[0,0] op_sel_hi:[0,1]
    v_cvt_pk_bf16_f32 v97, v102, v103
    ds_write_addtid_b32 v97 offset:3168
    v_pk_fma_f32 v[104:105], v[2:3], v[130:131], v[104:105] op_sel:[1,1,0] op_sel_hi:[1,0,1] neg_lo:[1,0,0]
    v_pk_mul_f32 v[106:107], v[2:3], v[162:163] op_sel:[0,0] op_sel_hi:[0,1]
    v_cvt_pk_bf16_f32 v98, v104, v105
    ds_write_addtid_b32 v98 offset:3456
    v_pk_fma_f32 v[106:107], v[2:3], v[162:163], v[106:107] op_sel:[1,1,0] op_sel_hi:[1,0,1] neg_lo:[1,0,0]
    v_pk_mul_f32 v[118:119], v[2:3], v[164:165] op_sel:[0,0] op_sel_hi:[0,1]
    v_cvt_pk_bf16_f32 v99, v106, v107
    ds_write_addtid_b32 v99 offset:3744
    v_pk_fma_f32 v[118:119], v[2:3], v[164:165], v[118:119] op_sel:[1,1,0] op_sel_hi:[1,0,1] neg_lo:[1,0,0]
    v_pk_mul_f32 v[120:121], v[2:3], v[166:167] op_sel:[0,0] op_sel_hi:[0,1]
    v_cvt_pk_bf16_f32 v100, v118, v119
    ds_write_addtid_b32 v100 offset:4032
    v_pk_fma_f32 v[120:121], v[2:3], v[166:167], v[120:121] op_sel:[1,1,0] op_sel_hi:[1,0,1] neg_lo:[1,0,0]
    v_cvt_pk_bf16_f32 v101, v120, v121
    ds_write_addtid_b32 v101 offset:4320
    ds_read_b128 v[62:65], v12 offset:0
    v_pk_mul_f32 v[110:111], v[108:109], v[108:109] op_sel:[0,0] op_sel_hi:[0,1]
    ds_read_b128 v[66:69], v12 offset:64
    v_pk_fma_f32 v[110:111], v[108:109], v[108:109], v[110:111] op_sel:[1,1,0] op_sel_hi:[1,0,1] neg_lo:[1,0,0]
    v_pk_mul_f32 v[122:123], v[116:117], v[110:111] op_sel:[0,0] op_sel_hi:[0,1]
    v_pk_fma_f32 v[122:123], v[116:117], v[110:111], v[122:123] op_sel:[1,1,0] op_sel_hi:[1,0,1] neg_lo:[1,0,0]
    ds_read_b128 v[70:73], v12 offset:128
    v_pk_mul_f32 v[124:125], v[134:135], v[110:111] op_sel:[0,0] op_sel_hi:[0,1]
    v_cvt_pk_bf16_f32 v94, v122, -v123
    v_pk_fma_f32 v[124:125], v[134:135], v[110:111], v[124:125] op_sel:[1,1,0] op_sel_hi:[1,0,1] neg_lo:[1,0,0]
    ds_read_b128 v[74:77], v12 offset:192
    v_pk_mul_f32 v[126:127], v[138:139], v[110:111] op_sel:[0,0] op_sel_hi:[0,1]
    v_cvt_pk_bf16_f32 v95, v124, -v125
    v_pk_fma_f32 v[126:127], v[138:139], v[110:111], v[126:127] op_sel:[1,1,0] op_sel_hi:[1,0,1] neg_lo:[1,0,0]
    ds_write_addtid_b32 v94 offset:0
    v_pk_mul_f32 v[128:129], v[142:143], v[110:111] op_sel:[0,0] op_sel_hi:[0,1]
    ds_write_addtid_b32 v95 offset:288
    v_cvt_pk_bf16_f32 v96, v126, -v127
    ds_write_addtid_b32 v96 offset:576
    v_pk_fma_f32 v[128:129], v[142:143], v[110:111], v[128:129] op_sel:[1,1,0] op_sel_hi:[1,0,1] neg_lo:[1,0,0]
    v_pk_mul_f32 v[130:131], v[146:147], v[110:111] op_sel:[0,0] op_sel_hi:[0,1]
    v_cvt_pk_bf16_f32 v97, v128, -v129
    ds_write_addtid_b32 v97 offset:864
    v_pk_fma_f32 v[130:131], v[146:147], v[110:111], v[130:131] op_sel:[1,1,0] op_sel_hi:[1,0,1] neg_lo:[1,0,0]
    v_pk_mul_f32 v[132:133], v[150:151], v[110:111] op_sel:[0,0] op_sel_hi:[0,1]
    v_cvt_pk_bf16_f32 v98, v130, -v131
    ds_write_addtid_b32 v98 offset:1152
    v_pk_fma_f32 v[132:133], v[150:151], v[110:111], v[132:133] op_sel:[1,1,0] op_sel_hi:[1,0,1] neg_lo:[1,0,0]
    v_pk_mul_f32 v[136:137], v[154:155], v[110:111] op_sel:[0,0] op_sel_hi:[0,1]
    v_cvt_pk_bf16_f32 v99, v132, -v133
    ds_write_addtid_b32 v99 offset:1440
    v_pk_fma_f32 v[136:137], v[154:155], v[110:111], v[136:137] op_sel:[1,1,0] op_sel_hi:[1,0,1] neg_lo:[1,0,0]
    v_pk_mul_f32 v[112:113], v[110:111], v[110:111] op_sel:[0,0] op_sel_hi:[0,1]
    v_pk_mul_f32 v[140:141], v[158:159], v[110:111] op_sel:[0,0] op_sel_hi:[0,1]
    v_cvt_pk_bf16_f32 v100, v136, -v137
    ds_write_addtid_b32 v100 offset:1728
    v_pk_fma_f32 v[112:113], v[110:111], v[110:111], v[112:113] op_sel:[1,1,0] op_sel_hi:[1,0,1] neg_lo:[1,0,0]
    v_pk_fma_f32 v[140:141], v[158:159], v[110:111], v[140:141] op_sel:[1,1,0] op_sel_hi:[1,0,1] neg_lo:[1,0,0]
    v_pk_mul_f32 v[144:145], v[116:117], v[112:113] op_sel:[0,0] op_sel_hi:[0,1]
    v_cvt_pk_bf16_f32 v101, v140, -v141
    ds_write_addtid_b32 v101 offset:2016
    v_pk_fma_f32 v[144:145], v[116:117], v[112:113], v[144:145] op_sel:[1,1,0] op_sel_hi:[1,0,1] neg_lo:[1,0,0]
    v_pk_mul_f32 v[148:149], v[138:139], v[112:113] op_sel:[0,0] op_sel_hi:[0,1]
    v_cvt_pk_bf16_f32 v94, v144, -v145
    ds_write_addtid_b32 v94 offset:2304
    v_pk_fma_f32 v[148:149], v[138:139], v[112:113], v[148:149] op_sel:[1,1,0] op_sel_hi:[1,0,1] neg_lo:[1,0,0]
    v_pk_mul_f32 v[152:153], v[146:147], v[112:113] op_sel:[0,0] op_sel_hi:[0,1]
    v_cvt_pk_bf16_f32 v95, v148, -v149
    ds_write_addtid_b32 v95 offset:2592
    v_pk_fma_f32 v[152:153], v[146:147], v[112:113], v[152:153] op_sel:[1,1,0] op_sel_hi:[1,0,1] neg_lo:[1,0,0]
    v_pk_mul_f32 v[156:157], v[154:155], v[112:113] op_sel:[0,0] op_sel_hi:[0,1]
    v_cvt_pk_bf16_f32 v96, v152, -v153
    ds_write_addtid_b32 v96 offset:2880
    v_pk_fma_f32 v[156:157], v[154:155], v[112:113], v[156:157] op_sel:[1,1,0] op_sel_hi:[1,0,1] neg_lo:[1,0,0]
    v_pk_mul_f32 v[160:161], v[122:123], v[112:113] op_sel:[0,0] op_sel_hi:[0,1]
    v_cvt_pk_bf16_f32 v97, v156, -v157
    ds_write_addtid_b32 v97 offset:3168
    v_pk_fma_f32 v[160:161], v[122:123], v[112:113], v[160:161] op_sel:[1,1,0] op_sel_hi:[1,0,1] neg_lo:[1,0,0]
    v_pk_mul_f32 v[162:163], v[126:127], v[112:113] op_sel:[0,0] op_sel_hi:[0,1]
    v_cvt_pk_bf16_f32 v98, v160, -v161
    ds_write_addtid_b32 v98 offset:3456
    v_pk_fma_f32 v[162:163], v[126:127], v[112:113], v[162:163] op_sel:[1,1,0] op_sel_hi:[1,0,1] neg_lo:[1,0,0]
    v_pk_mul_f32 v[164:165], v[130:131], v[112:113] op_sel:[0,0] op_sel_hi:[0,1]
    v_cvt_pk_bf16_f32 v99, v162, -v163
    ds_write_addtid_b32 v99 offset:3744
    v_pk_fma_f32 v[164:165], v[130:131], v[112:113], v[164:165] op_sel:[1,1,0] op_sel_hi:[1,0,1] neg_lo:[1,0,0]
    v_pk_mul_f32 v[166:167], v[136:137], v[112:113] op_sel:[0,0] op_sel_hi:[0,1]
    v_cvt_pk_bf16_f32 v100, v164, -v165
    ds_write_addtid_b32 v100 offset:4032
    v_pk_fma_f32 v[166:167], v[136:137], v[112:113], v[166:167] op_sel:[1,1,0] op_sel_hi:[1,0,1] neg_lo:[1,0,0]
    v_cvt_pk_bf16_f32 v101, v166, -v167
    ds_write_addtid_b32 v101 offset:4320
    ds_read_b128 v[78:81], v12 offset:0
    v_pk_mul_f32 v[114:115], v[112:113], v[112:113] op_sel:[0,0] op_sel_hi:[0,1]
    ds_read_b128 v[82:85], v12 offset:64
    v_pk_fma_f32 v[114:115], v[112:113], v[112:113], v[114:115] op_sel:[1,1,0] op_sel_hi:[1,0,1] neg_lo:[1,0,0]
    v_pk_mul_f32 v[2:3], v[116:117], v[114:115] op_sel:[0,0] op_sel_hi:[0,1]
    v_pk_fma_f32 v[2:3], v[116:117], v[114:115], v[2:3] op_sel:[1,1,0] op_sel_hi:[1,0,1] neg_lo:[1,0,0]
    ds_read_b128 v[86:89], v12 offset:128
    v_pk_mul_f32 v[4:5], v[146:147], v[114:115] op_sel:[0,0] op_sel_hi:[0,1]
    v_cvt_pk_bf16_f32 v94, v2, -v3
    v_pk_fma_f32 v[4:5], v[146:147], v[114:115], v[4:5] op_sel:[1,1,0] op_sel_hi:[1,0,1] neg_lo:[1,0,0]
    ds_read_b128 v[90:93], v12 offset:192
    v_pk_mul_f32 v[6:7], v[122:123], v[114:115] op_sel:[0,0] op_sel_hi:[0,1]
    v_cvt_pk_bf16_f32 v95, v4, -v5
    v_pk_fma_f32 v[6:7], v[122:123], v[114:115], v[6:7] op_sel:[1,1,0] op_sel_hi:[1,0,1] neg_lo:[1,0,0]
    ds_write_addtid_b32 v94 offset:0
    v_pk_mul_f32 v[102:103], v[130:131], v[114:115] op_sel:[0,0] op_sel_hi:[0,1]
    ds_write_addtid_b32 v95 offset:288
    v_cvt_pk_bf16_f32 v96, v6, -v7
    ds_write_addtid_b32 v96 offset:576
    v_pk_fma_f32 v[102:103], v[130:131], v[114:115], v[102:103] op_sel:[1,1,0] op_sel_hi:[1,0,1] neg_lo:[1,0,0]
    v_pk_mul_f32 v[104:105], v[144:145], v[114:115] op_sel:[0,0] op_sel_hi:[0,1]
    v_cvt_pk_bf16_f32 v97, v102, -v103
    ds_write_addtid_b32 v97 offset:864
    v_pk_fma_f32 v[104:105], v[144:145], v[114:115], v[104:105] op_sel:[1,1,0] op_sel_hi:[1,0,1] neg_lo:[1,0,0]
    v_pk_mul_f32 v[106:107], v[152:153], v[114:115] op_sel:[0,0] op_sel_hi:[0,1]
    v_cvt_pk_bf16_f32 v98, v104, -v105
    ds_write_addtid_b32 v98 offset:1152
    v_pk_fma_f32 v[106:107], v[152:153], v[114:115], v[106:107] op_sel:[1,1,0] op_sel_hi:[1,0,1] neg_lo:[1,0,0]
    v_pk_mul_f32 v[108:109], v[160:161], v[114:115] op_sel:[0,0] op_sel_hi:[0,1]
    v_cvt_pk_bf16_f32 v99, v106, -v107
    ds_write_addtid_b32 v99 offset:1440
    v_pk_fma_f32 v[108:109], v[160:161], v[114:115], v[108:109] op_sel:[1,1,0] op_sel_hi:[1,0,1] neg_lo:[1,0,0]
    v_pk_mul_f32 v[118:119], v[164:165], v[114:115] op_sel:[0,0] op_sel_hi:[0,1]
    v_cvt_pk_bf16_f32 v100, v108, -v109
    ds_write_addtid_b32 v100 offset:1728
    v_pk_fma_f32 v[118:119], v[164:165], v[114:115], v[118:119] op_sel:[1,1,0] op_sel_hi:[1,0,1] neg_lo:[1,0,0]
    v_pk_mul_f32 v[120:121], v[2:3], v[114:115] op_sel:[0,0] op_sel_hi:[0,1]
    v_cvt_pk_bf16_f32 v101, v118, -v119
    ds_write_addtid_b32 v101 offset:2016
    v_pk_fma_f32 v[120:121], v[2:3], v[114:115], v[120:121] op_sel:[1,1,0] op_sel_hi:[1,0,1] neg_lo:[1,0,0]
    v_cvt_pk_bf16_f32 v94, v120, -v121
    ds_write_addtid_b32 v94 offset:2304
    s_waitcnt lgkmcnt(15)
    v_mfma_f32_16x16x32_bf16 v[34:37], v[46:49], v[62:65], 0
    ds_read_b128 v[46:49], v12 offset:0
    s_waitcnt lgkmcnt(15)
    v_mfma_f32_16x16x32_bf16 v[34:37], v[50:53], v[66:69], v[34:37]
    ds_read_b128 v[50:53], v12 offset:64
    s_waitcnt lgkmcnt(15)
    v_mfma_f32_16x16x32_bf16 v[34:37], v[54:57], v[70:73], v[34:37]
    ds_read_b128 v[54:57], v12 offset:128
    s_waitcnt lgkmcnt(15)
    v_mfma_f32_16x16x32_bf16 v[34:37], v[58:61], v[74:77], v[34:37]
    s_waitcnt lgkmcnt(15)
    v_mfma_f32_16x16x32_bf16 v[38:41], v[78:81], v[62:65], 0
    ds_read_b128 v[58:61], v12 offset:192
    s_waitcnt lgkmcnt(15)
    v_mfma_f32_16x16x32_bf16 v[38:41], v[82:85], v[66:69], v[38:41]
    s_waitcnt lgkmcnt(14)
    v_mfma_f32_16x16x32_bf16 v[38:41], v[86:89], v[70:73], v[38:41]
    s_nop 0
    ds_write_b128 v13, v[34:37]
    s_waitcnt lgkmcnt(14)
    v_mfma_f32_16x16x32_bf16 v[38:41], v[90:93], v[74:77], v[38:41]
    s_waitcnt lgkmcnt(4)
    v_mfma_f32_16x16x32_bf16 v[42:45], v[62:65], v[46:49], 0
    s_waitcnt lgkmcnt(3)
    v_mfma_f32_16x16x32_bf16 v[42:45], v[66:69], v[50:53], v[42:45]
    s_waitcnt lgkmcnt(2)
    v_mfma_f32_16x16x32_bf16 v[42:45], v[70:73], v[54:57], v[42:45]
    s_nop 1
    ds_write_b64 v14, v[38:39]
    s_waitcnt lgkmcnt(2)
    v_mfma_f32_16x16x32_bf16 v[42:45], v[74:77], v[58:61], v[42:45]
    ds_write_b64 v15, v[40:41]
    s_nop 6
    ds_write_b128 v16, v[42:45]
    v_mov_b32 v2, 163504
    v_mov_b32 v3, 1
    s_mov_b64 exec, 1
    ds_add_rtn_u32 v3, v2, v3
    s_waitcnt lgkmcnt(0)
    v_readfirstlane_b32 s47, v3
    s_nop 0
    s_cmp_eq_u32 s47, 7
    s_cbranch_scc1 L_sync_k2_done
    s_mov_b32 s73, 1048576
L_sync_k2:
    ds_read_b32 v3, v2
    s_sub_u32 s73, s73, 1
    s_cbranch_scc1 L_sync_k2_done
    s_waitcnt lgkmcnt(0)
    v_readfirstlane_b32 s47, v3
    s_nop 0
    s_cmp_lt_u32 s47, 8
    s_cbranch_scc1 L_sync_k2
L_sync_k2_done:
    s_waitcnt lgkmcnt(0)
    s_mov_b64 exec, -1
    s_and_b32 s47, s44, 3
    s_cmp_eq_u32 s47, 3
    s_cbranch_scc1 L_nored_k
    ds_read_b128 v[32:35], v10 offset:0
    ds_read_b128 v[36:39], v10 offset:3408
    ds_read_b128 v[40:43], v10 offset:6816
    ds_read_b128 v[44:47], v10 offset:10224
    v_cmp_gt_u32 vcc, 163, v18
    s_nop 0
    s_mov_b64 s[64:65], vcc
    s_bitset0_b32 s65, 31
    v_cmp_eq_u32 vcc, 162, v18
    s_waitcnt lgkmcnt(2)
    v_add_f32 v32, v32, v36
    v_add_f32 v33, v33, v37
    v_add_f32 v34, v34, v38
    v_add_f32 v35, v35, v39
    s_waitcnt lgkmcnt(0)
    v_add_f32 v40, v40, v44
    v_add_f32 v41, v41, v45
    v_add_f32 v42, v42, v46
    v_add_f32 v43, v43, v47
    v_add_f32 v32, v32, v40
    v_add_f32 v33, v33, v41
    v_add_f32 v34, v34, v42
    v_add_f32 v35, v35, v43
    v_mov_b32 v2, 0
    s_nop 1
    v_mov_b32_dpp v2, v32 wave_shl:1 row_mask:0xf bank_mask:0xf
    v_cvt_pk_bf16_f32 v48, v32, v32
    v_cvt_pk_bf16_f32 v49, v32, v33
    v_cvt_pk_bf16_f32 v50, v33, v33
    v_cvt_pk_bf16_f32 v51, v33, v34
    v_cvt_pk_bf16_f32 v52, v34, v34
    v_cvt_pk_bf16_f32 v53, v34, v35
    v_cvt_pk_bf16_f32 v54, v35, v35
    v_cvt_pk_bf16_f32 v55, v35, v2
    v_cndmask_b32 v48, v48, 0, vcc
    s_mov_b64 exec, s[64:65]
    ds_write_b64 v11, v[48:49] offset:0
    ds_write_b64 v11, v[50:51] offset:8
    ds_write_b64 v11, v[52:53] offset:16
    ds_write_b64 v11, v[54:55] offset:24
    s_mov_b64 exec, -1
L_nored_k:
    v_mov_b32 v2, 163508
    v_mov_b32 v3, 1
    s_mov_b64 exec, 1
    ds_add_rtn_u32 v3, v2, v3
    s_waitcnt lgkmcnt(0)
    v_readfirstlane_b32 s47, v3
    s_nop 0
    s_cmp_eq_u32 s47, 7
    s_cbranch_scc1 L_sync_k3_done
    s_mov_b32 s73, 1048576
L_sync_k3:
    ds_read_b32 v3, v2
    s_sub_u32 s73, s73, 1
    s_cbranch_scc1 L_sync_k3_done
    s_waitcnt lgkmcnt(0)
    v_readfirstlane_b32 s47, v3
    s_nop 0
    s_cmp_lt_u32 s47, 8
    s_cbranch_scc1 L_sync_k3
L_sync_k3_done:
    s_waitcnt lgkmcnt(0)
    s_mov_b64 exec, -1
    ds_read_b32 v38, v17
    ds_read_b32 v39, v17
    ds_read_b32 v32, v20
    ds_read_b32 v33, v21
    ds_read_b32 v34, v22
    ds_read_b32 v35, v23
    ds_read_b32 v36, v24
    ds_read_b32 v37, v25
    s_waitcnt lgkmcnt(2)
    ds_write_b128 v9, v[32:35] offset:0
    v_alignbit_b32 v2, v33, v32, 16
    v_alignbit_b32 v3, v34, v33, 16
    v_alignbit_b32 v4, v35, v34, 16
    s_waitcnt lgkmcnt(2)
    v_alignbit_b32 v5, v36, v35, 16
    ds_write_b128 v9, v[2:5] offset:4160
    v_pk_mov_b32 v[10:11], v[32:33], v[34:35] op_sel:[1,0]
    s_waitcnt lgkmcnt(2)
    v_pk_mov_b32 v[12:13], v[34:35], v[36:37] op_sel:[1,0]
    ds_write_b128 v9, v[10:13] offset:8320
    v_pk_mov_b32 v[40:41], v[2:3], v[4:5] op_sel:[1,0]
    v_mov_b32 v42, v5
    v_alignbit_b32 v43, v37, v36, 16
    ds_write_b128 v9, v[40:43] offset:12480
    s_and_b32 s47, s44, 3
    s_cmp_lg_u32 s47, 3
    s_cbranch_scc1 L_notail_k
    s_mov_b32 exec_lo, 0
    s_mov_b32 exec_hi, 0x80000000
    ds_write_b128 v9, v[36:39] offset:16
    v_alignbit_b32 v2, v37, v36, 16
    v_alignbit_b32 v3, v38, v37, 16
    v_alignbit_b32 v4, v39, v38, 16
    v_alignbit_b32 v5, v39, v39, 16
    ds_write_b128 v9, v[2:5] offset:4176
    v_pk_mov_b32 v[10:11], v[36:37], v[38:39] op_sel:[1,0]
    v_pk_mov_b32 v[12:13], v[38:39], v[38:39] op_sel:[1,0]
    ds_write_b128 v9, v[10:13] offset:8336
    v_pk_mov_b32 v[40:41], v[2:3], v[4:5] op_sel:[1,0]
    v_mov_b32 v42, v5
    ds_write_b128 v9, v[40:43] offset:12496
    s_mov_b64 exec, -1
L_notail_k:
    s_cmp_lg_u32 s47, 0
    s_cbranch_scc1 L_nohead_k
    s_mov_b64 exec, 1
    v_mov_b32 v2, 0
    v_mov_b32 v3, 0
    v_mov_b32 v4, 0
    v_mov_b32 v5, 0
    v_subrev_u32 v10, 16, v9
    ds_write_b128 v10, v[2:5] offset:0
    ds_write_b128 v10, v[2:5] offset:4160
    ds_write_b128 v10, v[2:5] offset:8320
    ds_write_b128 v10, v[2:5] offset:12480
    s_mov_b64 exec, -1
L_nohead_k:
    s_nop 1
    s_branch F_help
F_kpost_end:
.p2align 12
I_tpost:
    s_cbranch_execz B_2
F_tpost:
    s_lshl_b32 s56, s42, 9
    s_add_u32 s28, s28, s56
    s_addc_u32 s29, s29, 0
    s_mul_i32 s47, s43, 57344
    s_lshl_b32 s56, s42, 7
    s_add_u32 s47, s47, s56
    v_add_u32 v7, s47, v7
    s_mov_b32 s48, s24
    s_mov_b32 s49, s25
    s_mov_b32 s50, 1835008
    s_mov_b32 s51, 0x20000
    global_load_dwordx4 v[64:67], v12, s[28:29] offset:0
    global_load_dwordx4 v[68:71], v12, s[28:29] offset:16
    global_load_dwordx4 v[72:75], v12, s[28:29] offset:32
    global_load_dwordx4 v[76:79], v12, s[28:29] offset:48
    buffer_load_dwordx4 v[40:43], v7, s[48:51], 0 offen nt
    buffer_load_dwordx4 v[44:47], v7, s[48:51], 0 offen offset:896 nt
    global_load_dwordx4 v[48:51], v7, s[26:27] offset:0 nt
    global_load_dwordx4 v[52:55], v7, s[26:27] offset:896 nt
    global_load_dwordx4 v[56:59], v7, s[4:5] offset:0 nt
    global_load_dwordx4 v[60:63], v7, s[4:5] offset:896 nt
    v_subrev_u32 v2, 896, v7
    buffer_load_dwordx4 v[36:39], v2, s[48:51], 0 offen
    v_subrev_u32 v2, 1792, v7
    buffer_load_dwordx4 v[32:35], v2, s[48:51], 0 offen
    v_subrev_u32 v2, 2688, v7
    buffer_load_dwordx4 v[14:17], v2, s[48:51], 0 offen
    s_lshl_b32 s47, s42, 18
    s_lshl_b32 s56, s43, 7
    s_sub_u32 s47, s47, s56
    s_add_u32 s47, s47, 3968
    v_add_u32 v11, s47, v11
    s_mov_b32 s70, 0x05040100
    s_mov_b32 s71, 0x07060302
    s_mov_b64 exec, 0
    s_cmp_eq_u32 s44, 0
    s_cbranch_scc1 I_c15
    s_cmp_eq_u32 s44, 1
    s_cbranch_scc1 I_c105
    s_cmp_eq_u32 s44, 2
    s_cbranch_scc1 I_c195
    s_cmp_eq_u32 s44, 3
    s_cbranch_scc1 I_c285
B_walk:
    s_mov_b64 exec, -1
    s_setprio 2
    s_lshr_b32 s47, s44, 1
    s_mul_i32 s47, s47, 448
    s_and_b32 s56, s44, 1
    s_add_u32 s47, s47, s56
    s_add_u32 s47, s47, s45
    s_lshl_b32 s47, s47, 12
    s_mul_i32 s56, s22, 3670016
    s_add_u32 s47, s47, s56
    v_lshl_add_u32 v2, v1, 4, s47
    v_mov_b32 v80, 1
    v_mov_b32 v81, 2
    v_mov_b32 v82, 3
    v_mov_b32 v83, 4
    v_mov_b32 v84, 5
    v_mov_b32 v85, 6
    v_mov_b32 v86, 7
    s_mul_i32 s57, s22, 3670016
    s_add_u32 s47, s57, 0
    s_add_u32 s6, s40, s47
    s_addc_u32 s7, s41, 0
    s_add_u32 s47, s57, 131072
    s_add_u32 s8, s40, s47
    s_addc_u32 s9, s41, 0
    s_add_u32 s47, s57, 1835008
    s_add_u32 s10, s40, s47
    s_addc_u32 s11, s41, 0
    s_add_u32 s47, s57, 1966080
    s_add_u32 s12, s40, s47
    s_addc_u32 s13, s41, 0
    s_or_b32 s23, s63, 0xc0
    s_waitcnt vmcnt(12)
    v_lshlrev_b32 v88, 16, v64
    v_and_b32 v96, s46, v64
    v_lshlrev_b32 v104, 16, v65
    v_and_b32 v112, s46, v65
    v_lshlrev_b32 v89, 16, v66
    v_and_b32 v97, s46, v66
    v_lshlrev_b32 v105, 16, v67
    v_and_b32 v113, s46, v67
    s_waitcnt vmcnt(11)
    v_lshlrev_b32 v90, 16, v68
    v_and_b32 v98, s46, v68
    v_lshlrev_b32 v106, 16, v69
    v_and_b32 v114, s46, v69
    v_lshlrev_b32 v91, 16, v70
    v_and_b32 v99, s46, v70
    v_lshlrev_b32 v107, 16, v71
    v_and_b32 v115, s46, v71
    s_waitcnt vmcnt(10)
    v_lshlrev_b32 v92, 16, v72
    v_and_b32 v100, s46, v72
    v_lshlrev_b32 v108, 16, v73
    v_and_b32 v116, s46, v73
    v_lshlrev_b32 v93, 16, v74
    v_and_b32 v101, s46, v74
    v_lshlrev_b32 v109, 16, v75
    v_and_b32 v117, s46, v75
    s_waitcnt vmcnt(9)
    v_lshlrev_b32 v94, 16, v76
    v_and_b32 v102, s46, v76
    v_lshlrev_b32 v110, 16, v77
    v_and_b32 v118, s46, v77
    v_lshlrev_b32 v95, 16, v78
    v_and_b32 v103, s46, v78
    v_lshlrev_b32 v111, 16, v79
    v_and_b32 v119, s46, v79
    s_mul_i32 s47, s44, 5120
    s_add_u32 s47, s47, 103424
    s_mov_b32 m0, s47
    s_nop 0
    s_waitcnt vmcnt(0)
    s_lshl_b32 s47, s45, 12
    s_add_u32 s52, s30, s47
    s_addc_u32 s53, s31, 0
    s_mov_b32 s54, 4096
    s_mov_b32 s55, 0x20000
    s_add_u32 s47, s47, 4096
    s_add_u32 s48, s30, s47
    s_addc_u32 s49, s31, 0
    s_mov_b32 s50, 4096
    s_mov_b32 s51, 0x20000
    v_subrev_u32 v3, 16, v5
    buffer_load_dwordx4 v[64:67], v3, s[52:55], 0 offen nt
    buffer_load_dwordx4 v[68:71], v5, s[52:55], 0 offen nt
    buffer_load_dwordx4 v[72:75], v3, s[48:51], 0 offen nt
    buffer_load_dwordx4 v[76:79], v5, s[48:51], 0 offen nt
    v_lshlrev_b32 v124, 16, v40
    v_and_b32 v125, s46, v40
    v_lshlrev_b32 v126, 16, v44
    v_and_b32 v127, s46, v44
    v_lshlrev_b32 v122, 16, v36
    v_and_b32 v123, s46, v36
    v_pk_mul_f32 v[132:133], v[124:125], v[88:89]
    v_pk_mul_f32 v[134:135], v[126:127], v[88:89]
    v_lshlrev_b32 v120, 16, v32
    v_and_b32 v121, s46, v32
    v_pk_fma_f32 v[132:133], v[122:123], v[96:97], v[132:133]
    v_pk_fma_f32 v[134:135], v[124:125], v[96:97], v[134:135]
    v_lshlrev_b32 v12, 16, v14
    v_and_b32 v13, s46, v14
    v_pk_fma_f32 v[132:133], v[120:121], v[104:105], v[132:133]
    v_pk_fma_f32 v[134:135], v[122:123], v[104:105], v[134:135]
    v_pk_fma_f32 v[132:133], v[12:13], v[112:113], v[132:133]
    v_pk_fma_f32 v[134:135], v[120:121], v[112:113], v[134:135]
    v_lshlrev_b32 v128, 16, v48
    v_and_b32 v129, s46, v48
    v_lshlrev_b32 v130, 16, v52
    v_and_b32 v131, s46, v52
    v_pk_mul_f32 v[132:133], v[132:133], v[128:129]
    v_pk_mul_f32 v[134:135], v[134:135], v[130:131]
    v_cvt_pk_bf16_f32 v136, v134, v132
    ds_write_b32 v8, v136 offset:10240
    v_cvt_pk_bf16_f32 v137, v135, v133
    ds_write_b32 v8, v137 offset:10368
    v_lshlrev_b32 v124, 16, v41
    v_and_b32 v125, s46, v41
    v_lshlrev_b32 v126, 16, v45
    v_and_b32 v127, s46, v45
    v_lshlrev_b32 v122, 16, v37
    v_and_b32 v123, s46, v37
    v_pk_mul_f32 v[132:133], v[124:125], v[90:91]
    v_pk_mul_f32 v[134:135], v[126:127], v[90:91]
    v_lshlrev_b32 v120, 16, v33
    v_and_b32 v121, s46, v33
    v_pk_fma_f32 v[132:133], v[122:123], v[98:99], v[132:133]
    v_pk_fma_f32 v[134:135], v[124:125], v[98:99], v[134:135]
    v_lshlrev_b32 v12, 16, v15
    v_and_b32 v13, s46, v15
    v_pk_fma_f32 v[132:133], v[120:121], v[106:107], v[132:133]
    v_pk_fma_f32 v[134:135], v[122:123], v[106:107], v[134:135]
    v_pk_fma_f32 v[132:133], v[12:13], v[114:115], v[132:133]
    v_pk_fma_f32 v[134:135], v[120:121], v[114:115], v[134:135]
    v_lshlrev_b32 v128, 16, v49
    v_and_b32 v129, s46, v49
    v_lshlrev_b32 v130, 16, v53
    v_and_b32 v131, s46, v53
    v_pk_mul_f32 v[132:133], v[132:133], v[128:129]
    v_pk_mul_f32 v[134:135], v[134:135], v[130:131]
    v_cvt_pk_bf16_f32 v138, v134, v132
    ds_write_b32 v8, v138 offset:10496
    v_cvt_pk_bf16_f32 v139, v135, v133
    ds_write_b32 v8, v139 offset:10624
    v_lshlrev_b32 v124, 16, v42
    v_and_b32 v125, s46, v42
    v_lshlrev_b32 v126, 16, v46
    v_and_b32 v127, s46, v46
    v_lshlrev_b32 v122, 16, v38
    v_and_b32 v123, s46, v38
    v_pk_mul_f32 v[132:133], v[124:125], v[92:93]
    v_pk_mul_f32 v[134:135], v[126:127], v[92:93]
    v_lshlrev_b32 v120, 16, v34
    v_and_b32 v121, s46, v34
    v_pk_fma_f32 v[132:133], v[122:123], v[100:101], v[132:133]
    v_pk_fma_f32 v[134:135], v[124:125], v[100:101], v[134:135]
    v_lshlrev_b32 v12, 16, v16
    v_and_b32 v13, s46, v16
    v_pk_fma_f32 v[132:133], v[120:121], v[108:109], v[132:133]
    v_pk_fma_f32 v[134:135], v[122:123], v[108:109], v[134:135]
    v_pk_fma_f32 v[132:133], v[12:13], v[116:117], v[132:133]
    v_pk_fma_f32 v[134:135], v[120:121], v[116:117], v[134:135]
    v_lshlrev_b32 v128, 16, v50
    v_and_b32 v129, s46, v50
    v_lshlrev_b32 v130, 16, v54
    v_and_b32 v131, s46, v54
    v_pk_mul_f32 v[132:133], v[132:133], v[128:129]
    v_pk_mul_f32 v[134:135], v[134:135], v[130:131]
    v_cvt_pk_bf16_f32 v136, v134, v132
    ds_write_b32 v8, v136 offset:10752
    v_cvt_pk_bf16_f32 v137, v135, v133
    ds_write_b32 v8, v137 offset:10880
    v_lshlrev_b32 v124, 16, v43
    v_and_b32 v125, s46, v43
    v_lshlrev_b32 v126, 16, v47
    v_and_b32 v127, s46, v47
    v_lshlrev_b32 v122, 16, v39
    v_and_b32 v123, s46, v39
    v_pk_mul_f32 v[132:133], v[124:125], v[94:95]
    v_pk_mul_f32 v[134:135], v[126:127], v[94:95]
    v_lshlrev_b32 v120, 16, v35
    v_and_b32 v121, s46, v35
    v_pk_fma_f32 v[132:133], v[122:123], v[102:103], v[132:133]
    v_pk_fma_f32 v[134:135], v[124:125], v[102:103], v[134:135]
    v_lshlrev_b32 v12, 16, v17
    v_and_b32 v13, s46, v17
    v_pk_fma_f32 v[132:133], v[120:121], v[110:111], v[132:133]
    v_pk_fma_f32 v[134:135], v[122:123], v[110:111], v[134:135]
    v_pk_fma_f32 v[132:133], v[12:13], v[118:119], v[132:133]
    v_pk_fma_f32 v[134:135], v[120:121], v[118:119], v[134:135]
    v_lshlrev_b32 v128, 16, v51
    v_and_b32 v129, s46, v51
    v_lshlrev_b32 v130, 16, v55
    v_and_b32 v131, s46, v55
    v_pk_mul_f32 v[132:133], v[132:133], v[128:129]
    v_pk_mul_f32 v[134:135], v[134:135], v[130:131]
    v_cvt_pk_bf16_f32 v138, v134, v132
    ds_write_b32 v8, v138 offset:11008
    v_cvt_pk_bf16_f32 v139, v135, v133
    ds_write_b32 v8, v139 offset:11136
    v_perm_b32 v136, v56, v60, s70
    ds_write_b32 v8, v136 offset:0
    v_perm_b32 v137, v56, v60, s71
    ds_write_b32 v8, v137 offset:128
    v_perm_b32 v138, v57, v61, s70
    ds_write_b32 v8, v138 offset:256
    v_perm_b32 v139, v57, v61, s71
    ds_write_b32 v8, v139 offset:384
    v_perm_b32 v136, v58, v62, s70
    ds_write_b32 v8, v136 offset:512
    v_perm_b32 v137, v58, v62, s71
    ds_write_b32 v8, v137 offset:640
    v_perm_b32 v138, v59, v63, s70
    ds_write_b32 v8, v138 offset:768
    v_perm_b32 v139, v59, v63, s71
    ds_write_b32 v8, v139 offset:896
    s_setprio 0
    v_mov_b32 v3, 163488
    v_mov_b32 v4, 1
    s_mov_b64 exec, 1
    ds_add_rtn_u32 v4, v3, v4
    s_waitcnt lgkmcnt(0)
    v_readfirstlane_b32 s47, v4
    s_nop 0
    s_cmp_eq_u32 s47, 3
    s_cbranch_scc1 L_sync_tr_done
    s_mov_b32 s73, 1048576
L_sync_tr:
    ds_read_b32 v4, v3
    s_sub_u32 s73, s73, 1
    s_cbranch_scc1 L_sync_tr_done
    s_waitcnt lgkmcnt(0)
    v_readfirstlane_b32 s47, v4
    s_nop 0
    s_cmp_lt_u32 s47, 4
    s_cbranch_scc1 L_sync_tr
L_sync_tr_done:
    s_waitcnt lgkmcnt(0)
    s_mov_b64 exec, -1
    s_setprio 2
    ds_read_b128 v[12:15], v9 offset:0
    ds_read_b128 v[32:35], v10 offset:0
    ds_read_b128 v[36:39], v9 offset:10240
    ds_read_b128 v[40:43], v10 offset:10240
    s_cmp_lg_u32 s22, 0
    s_cbranch_scc1 F_static
    s_waitcnt lgkmcnt(3)
    global_store_dwordx4 v11, v[12:15], s[6:7]
    s_waitcnt lgkmcnt(2)
    global_store_dwordx4 v11, v[32:35], s[8:9]
    s_waitcnt lgkmcnt(1)
    global_store_dwordx4 v11, v[36:39], s[10:11]
    s_waitcnt lgkmcnt(0)
    global_store_dwordx4 v11, v[40:43], s[12:13]
    s_waitcnt vmcnt(0)
    v_mov_b32 v3, 163492
    v_mov_b32 v4, 1
    s_mov_b64 exec, 1
    ds_add_rtn_u32 v4, v3, v4
    v_mov_b32 v3, s2
    s_waitcnt lgkmcnt(0)
    v_readfirstlane_b32 s56, v4
    v_mov_b32 v4, s23
    s_cmp_lg_u32 s56, 3
    s_cbranch_scc1 L_nosig_loc
    global_store_byte v3, v4, s[38:39]
L_nosig_loc:
    s_mov_b64 exec, -1
    s_setprio 0
    ds_write_b128 v6, v[64:67] offset:33280
    v_alignbit_b32 v44, v65, v64, 16
    v_alignbit_b32 v45, v66, v65, 16
    v_alignbit_b32 v46, v67, v66, 16
    v_alignbit_b32 v47, v68, v67, 16
    ds_write_b128 v6, v[44:47] offset:37440
    v_pk_mov_b32 v[48:49], v[64:65], v[66:67] op_sel:[1,0]
    v_pk_mov_b32 v[50:51], v[66:67], v[68:69] op_sel:[1,0]
    ds_write_b128 v6, v[48:51] offset:41600
    v_pk_mov_b32 v[52:53], v[44:45], v[46:47] op_sel:[1,0]
    v_mov_b32 v54, v47
    v_alignbit_b32 v55, v69, v68, 16
    ds_write_b128 v6, v[52:55] offset:45760
    ds_write_b128 v6, v[72:75] offset:49920
    v_alignbit_b32 v44, v73, v72, 16
    v_alignbit_b32 v45, v74, v73, 16
    v_alignbit_b32 v46, v75, v74, 16
    v_alignbit_b32 v47, v76, v75, 16
    ds_write_b128 v6, v[44:47] offset:54080
    v_pk_mov_b32 v[48:49], v[72:73], v[74:75] op_sel:[1,0]
    v_pk_mov_b32 v[50:51], v[74:75], v[76:77] op_sel:[1,0]
    ds_write_b128 v6, v[48:51] offset:58240
    v_pk_mov_b32 v[52:53], v[44:45], v[46:47] op_sel:[1,0]
    v_mov_b32 v54, v47
    v_alignbit_b32 v55, v77, v76, 16
    ds_write_b128 v6, v[52:55] offset:62400
    s_and_b32 s47, s44, 3
    s_cmp_lg_u32 s47, 3
    s_cbranch_scc1 L_notail_b
    s_mov_b32 exec_lo, 0
    s_mov_b32 exec_hi, 0x80000000
    ds_write_b128 v6, v[68:71] offset:33296
    v_alignbit_b32 v44, v69, v68, 16
    v_alignbit_b32 v45, v70, v69, 16
    v_alignbit_b32 v46, v71, v70, 16
    v_alignbit_b32 v47, v71, v71, 16
    ds_write_b128 v6, v[44:47] offset:37456
    v_pk_mov_b32 v[48:49], v[68:69], v[70:71] op_sel:[1,0]
    v_pk_mov_b32 v[50:51], v[70:71], v[70:71] op_sel:[1,0]
    ds_write_b128 v6, v[48:51] offset:41616
    v_pk_mov_b32 v[52:53], v[44:45], v[46:47] op_sel:[1,0]
    v_mov_b32 v54, v47
    ds_write_b128 v6, v[52:55] offset:45776
    ds_write_b128 v6, v[76:79] offset:49936
    v_alignbit_b32 v44, v77, v76, 16
    v_alignbit_b32 v45, v78, v77, 16
    v_alignbit_b32 v46, v79, v78, 16
    v_alignbit_b32 v47, v79, v79, 16
    ds_write_b128 v6, v[44:47] offset:54096
    v_pk_mov_b32 v[48:49], v[76:77], v[78:79] op_sel:[1,0]
    v_pk_mov_b32 v[50:51], v[78:79], v[78:79] op_sel:[1,0]
    ds_write_b128 v6, v[48:51] offset:58256
    v_pk_mov_b32 v[52:53], v[44:45], v[46:47] op_sel:[1,0]
    v_mov_b32 v54, v47
    ds_write_b128 v6, v[52:55] offset:62416
    s_mov_b64 exec, -1
L_notail_b:
    s_cmp_lg_u32 s47, 0
    s_cbranch_scc1 L_nohead_b
    s_mov_b64 exec, 1
    v_mov_b32 v44, 0
    v_mov_b32 v45, 0
    v_mov_b32 v46, 0
    v_mov_b32 v47, 0
    v_subrev_u32 v48, 16, v6
    ds_write_b128 v48, v[44:47] offset:33280
    ds_write_b128 v48, v[44:47] offset:37440
    ds_write_b128 v48, v[44:47] offset:41600
    ds_write_b128 v48, v[44:47] offset:45760
    ds_write_b128 v48, v[44:47] offset:49920
    ds_write_b128 v48, v[44:47] offset:54080
    ds_write_b128 v48, v[44:47] offset:58240
    ds_write_b128 v48, v[44:47] offset:62400
    s_mov_b64 exec, -1
L_nohead_b:
    s_nop 1
    v_lshlrev_b32 v3, 2, v1
    global_load_dword v4, v3, s[38:39] sc1
    s_mov_b32 s73, 0
L_ready:
    s_waitcnt vmcnt(0)
    v_cmp_eq_u32_sdwa s[48:49], v4, s23 src0_sel:BYTE_0 src1_sel:DWORD
    v_cmp_eq_u32_sdwa s[50:51], v4, s23 src0_sel:BYTE_1 src1_sel:DWORD
    v_cmp_eq_u32_sdwa s[52:53], v4, s23 src0_sel:BYTE_2 src1_sel:DWORD
    v_cmp_eq_u32_sdwa s[54:55], v4, s23 src0_sel:BYTE_3 src1_sel:DWORD
    s_bcnt1_i32_b64 s47, s[48:49]
    s_bcnt1_i32_b64 s56, s[50:51]
    s_add_u32 s47, s47, s56
    s_bcnt1_i32_b64 s56, s[52:53]
    s_add_u32 s47, s47, s56
    s_bcnt1_i32_b64 s56, s[54:55]
    s_add_u32 s47, s47, s56
    s_cmp_eq_u32 s47, 32
    s_cbranch_scc1 L_ready_ok
    global_load_dword v4, v3, s[38:39] sc1
    s_add_u32 s73, s73, 1
    s_cmp_lt_u32 s73, 65536
    s_cbranch_scc1 L_ready
    s_waitcnt vmcnt(0)
L_ready_ok:
F_stage:
    global_load_lds_dwordx4 v2, s[40:41] offset:0 sc1
    global_load_lds_dwordx4 v2, s[40:41] offset:1024 sc1
    global_load_lds_dwordx4 v2, s[40:41] offset:2048 sc1
    global_load_lds_dwordx4 v2, s[40:41] offset:3072 sc1
    s_waitcnt vmcnt(0) lgkmcnt(0)
    s_barrier
    s_setprio 1
    s_branch F_conv
F_tpost_end:
.p2align 12
I_conv:
    s_cbranch_execz I_conv2
F_conv:
    ds_read_b64 v[2:3], v19 offset:0
    ds_read_b64 v[4:5], v19 offset:8
    ds_read_b128 v[76:79], v26 offset:0
    ds_read_b64 v[6:7], v19 offset:64
    ds_read_b64 v[8:9], v19 offset:72
    ds_read_b128 v[88:91], v26 offset:64
    ds_read_b64 v[10:11], v19 offset:128
    ds_read_b64 v[12:13], v19 offset:136
    ds_read_b128 v[92:95], v26 offset:128
    ds_read_b64 v[14:15], v19 offset:192
    ds_read_b64 v[16:17], v19 offset:200
    ds_read_b128 v[96:99], v26 offset:192
    s_waitcnt lgkmcnt(9)
    v_mfma_f32_16x16x32_bf16 v[124:127], v[2:5], v[76:79], 0
    ds_read_b128 v[100:103], v20 offset:3584
    s_waitcnt lgkmcnt(7)
    v_mfma_f32_16x16x32_bf16 v[124:127], v[6:9], v[88:91], v[124:127]
    ds_read_b64 v[32:33], v19 offset:256
    ds_read_b64 v[34:35], v19 offset:264
    ds_read_b128 v[104:107], v26 offset:256
    v_mfma_f32_16x16x32_bf16 v[128:131], v[2:5], v[88:91], 0
    ds_read_b128 v[108:111], v20 offset:3648
    s_waitcnt lgkmcnt(8)
    v_mfma_f32_16x16x32_bf16 v[124:127], v[10:13], v[92:95], v[124:127]
    ds_read_b64 v[36:37], v19 offset:320
    v_mfma_f32_16x16x32_bf16 v[128:131], v[6:9], v[92:95], v[128:131]
    ds_read_b64 v[38:39], v19 offset:328
    v_mfma_f32_16x16x32_bf16 v[132:135], v[2:5], v[92:95], 0
    ds_read_b128 v[112:115], v26 offset:320
    s_waitcnt lgkmcnt(8)
    v_mfma_f32_16x16x32_bf16 v[124:127], v[14:17], v[96:99], v[124:127]
    ds_read_b128 v[76:79], v20 offset:3712
    v_mfma_f32_16x16x32_bf16 v[128:131], v[10:13], v[96:99], v[128:131]
    ds_read_b64 v[40:41], v19 offset:384
    v_mfma_f32_16x16x32_bf16 v[132:135], v[6:9], v[96:99], v[132:135]
    ds_read_b64 v[42:43], v19 offset:392
    v_mfma_f32_16x16x32_bf16 v[136:139], v[2:5], v[96:99], 0
    ds_read_b128 v[88:91], v26 offset:384
    s_waitcnt lgkmcnt(11)
    v_mfma_f32_16x16x32_bf16 v[140:143], v[2:5], v[100:103], 0
    s_waitcnt lgkmcnt(8)
    v_mfma_f32_16x16x32_bf16 v[124:127], v[32:35], v[104:107], v[124:127]
    v_mfma_f32_16x16x32_bf16 v[128:131], v[14:17], v[104:107], v[128:131]
    v_mfma_f32_16x16x32_bf16 v[132:135], v[10:13], v[104:107], v[132:135]
    v_mfma_f32_16x16x32_bf16 v[136:139], v[6:9], v[104:107], v[136:139]
    ds_read_b128 v[92:95], v20 offset:3776
I_c15:
    s_cbranch_execz I_c45
    v_mfma_f32_16x16x32_bf16 v[144:147], v[2:5], v[104:107], 0
    ds_read_b64 v[44:45], v19 offset:448
    s_waitcnt lgkmcnt(9)
    v_mfma_f32_16x16x32_bf16 v[140:143], v[6:9], v[108:111], v[140:143]
    ds_read_b64 v[46:47], v19 offset:456
    s_waitcnt lgkmcnt(7)
    v_mfma_f32_16x16x32_bf16 v[124:127], v[36:39], v[112:115], v[124:127]
    ds_read_b128 v[96:99], v26 offset:448
    v_mfma_f32_16x16x32_bf16 v[128:131], v[32:35], v[112:115], v[128:131]
    v_mfma_f32_16x16x32_bf16 v[132:135], v[14:17], v[112:115], v[132:135]
    v_mfma_f32_16x16x32_bf16 v[136:139], v[10:13], v[112:115], v[136:139]
    v_mfma_f32_16x16x32_bf16 v[144:147], v[6:9], v[112:115], v[144:147]
    v_mfma_f32_16x16x32_bf16 v[148:151], v[2:5], v[112:115], 0
    ds_read_b128 v[100:103], v20 offset:3840
    s_waitcnt lgkmcnt(8)
    v_mfma_f32_16x16x32_bf16 v[140:143], v[10:13], v[76:79], v[140:143]
    ds_read_b64 v[48:49], v19 offset:512
    s_waitcnt lgkmcnt(6)
    v_mfma_f32_16x16x32_bf16 v[124:127], v[40:43], v[88:91], v[124:127]
    ds_read_b64 v[50:51], v19 offset:520
    v_mfma_f32_16x16x32_bf16 v[128:131], v[36:39], v[88:91], v[128:131]
    ds_read_b128 v[104:107], v26 offset:512
    v_mfma_f32_16x16x32_bf16 v[132:135], v[32:35], v[88:91], v[132:135]
    v_mfma_f32_16x16x32_bf16 v[136:139], v[14:17], v[88:91], v[136:139]
    v_mfma_f32_16x16x32_bf16 v[144:147], v[10:13], v[88:91], v[144:147]
    v_mfma_f32_16x16x32_bf16 v[148:151], v[6:9], v[88:91], v[148:151]
    v_mfma_f32_16x16x32_bf16 v[152:155], v[2:5], v[88:91], 0
    ds_read_b128 v[108:111], v20 offset:3904
    s_waitcnt lgkmcnt(8)
    v_mfma_f32_16x16x32_bf16 v[140:143], v[14:17], v[92:95], v[140:143]
    ds_read_b64 v[52:53], v19 offset:576
    s_waitcnt lgkmcnt(6)
    v_mfma_f32_16x16x32_bf16 v[124:127], v[44:47], v[96:99], v[124:127]
    ds_read_b64 v[54:55], v19 offset:584
    v_mfma_f32_16x16x32_bf16 v[128:131], v[40:43], v[96:99], v[128:131]
    ds_read_b128 v[112:115], v26 offset:576
    v_mfma_f32_16x16x32_bf16 v[132:135], v[36:39], v[96:99], v[132:135]
    v_mfma_f32_16x16x32_bf16 v[136:139], v[32:35], v[96:99], v[136:139]
    v_mfma_f32_16x16x32_bf16 v[144:147], v[14:17], v[96:99], v[144:147]
    v_mfma_f32_16x16x32_bf16 v[148:151], v[10:13], v[96:99], v[148:151]
    v_mfma_f32_16x16x32_bf16 v[152:155], v[6:9], v[96:99], v[152:155]
    ds_read_b128 v[76:79], v20 offset:3968
    s_waitcnt lgkmcnt(8)
    v_mfma_f32_16x16x32_bf16 v[140:143], v[32:35], v[100:103], v[140:143]
    ds_read_b64 v[56:57], v19 offset:640
    s_waitcnt lgkmcnt(6)
    v_mfma_f32_16x16x32_bf16 v[124:127], v[48:51], v[104:107], v[124:127]
    ds_read_b64 v[58:59], v19 offset:648
    v_mfma_f32_16x16x32_bf16 v[128:131], v[44:47], v[104:107], v[128:131]
    ds_read_b128 v[88:91], v26 offset:640
    v_mfma_f32_16x16x32_bf16 v[132:135], v[40:43], v[104:107], v[132:135]
    v_mfma_f32_16x16x32_bf16 v[136:139], v[36:39], v[104:107], v[136:139]
    v_mfma_f32_16x16x32_bf16 v[144:147], v[32:35], v[104:107], v[144:147]
I_c45:
    s_cbranch_execz I_c75
    v_mfma_f32_16x16x32_bf16 v[148:151], v[14:17], v[104:107], v[148:151]
    v_mfma_f32_16x16x32_bf16 v[152:155], v[10:13], v[104:107], v[152:155]
    ds_read_b128 v[92:95], v20 offset:4032
    s_waitcnt lgkmcnt(8)
    v_mfma_f32_16x16x32_bf16 v[140:143], v[36:39], v[108:111], v[140:143]
    ds_read_b64 v[60:61], v19 offset:704
    s_waitcnt lgkmcnt(6)
    v_mfma_f32_16x16x32_bf16 v[124:127], v[52:55], v[112:115], v[124:127]
    ds_read_b64 v[62:63], v19 offset:712
    v_mfma_f32_16x16x32_bf16 v[128:131], v[48:51], v[112:115], v[128:131]
    ds_read_b128 v[96:99], v26 offset:704
    v_mfma_f32_16x16x32_bf16 v[132:135], v[44:47], v[112:115], v[132:135]
    v_mfma_f32_16x16x32_bf16 v[136:139], v[40:43], v[112:115], v[136:139]
    v_mfma_f32_16x16x32_bf16 v[144:147], v[36:39], v[112:115], v[144:147]
    v_mfma_f32_16x16x32_bf16 v[148:151], v[32:35], v[112:115], v[148:151]
    v_mfma_f32_16x16x32_bf16 v[152:155], v[14:17], v[112:115], v[152:155]
    ds_read_b64 v[64:65], v19 offset:3584
    s_waitcnt lgkmcnt(8)
    v_mfma_f32_16x16x32_bf16 v[140:143], v[40:43], v[76:79], v[140:143]
    ds_read_b64 v[66:67], v19 offset:3592
    s_waitcnt lgkmcnt(6)
    v_mfma_f32_16x16x32_bf16 v[124:127], v[56:59], v[88:91], v[124:127]
    ds_read_b128 v[100:103], v20 offset:3584
    v_mfma_f32_16x16x32_bf16 v[128:131], v[52:55], v[88:91], v[128:131]
    ds_read_b64 v[68:69], v19 offset:768
    v_mfma_f32_16x16x32_bf16 v[132:135], v[48:51], v[88:91], v[132:135]
    ds_read_b64 v[70:71], v19 offset:776
    v_mfma_f32_16x16x32_bf16 v[136:139], v[44:47], v[88:91], v[136:139]
    ds_read_b128 v[104:107], v26 offset:768
    v_mfma_f32_16x16x32_bf16 v[144:147], v[40:43], v[88:91], v[144:147]
    v_mfma_f32_16x16x32_bf16 v[148:151], v[36:39], v[88:91], v[148:151]
    v_mfma_f32_16x16x32_bf16 v[152:155], v[32:35], v[88:91], v[152:155]
    ds_read_b64 v[72:73], v19 offset:3648
    s_waitcnt lgkmcnt(10)
    v_mfma_f32_16x16x32_bf16 v[140:143], v[44:47], v[92:95], v[140:143]
    ds_read_b64 v[74:75], v19 offset:3656
    s_waitcnt lgkmcnt(8)
    v_mfma_f32_16x16x32_bf16 v[124:127], v[60:63], v[96:99], v[124:127]
    ds_read_b128 v[108:111], v20 offset:3648
    v_mfma_f32_16x16x32_bf16 v[128:131], v[56:59], v[96:99], v[128:131]
    ds_read_b64 v[2:3], v19 offset:832
    v_mfma_f32_16x16x32_bf16 v[132:135], v[52:55], v[96:99], v[132:135]
    ds_read_b64 v[4:5], v19 offset:840
    v_mfma_f32_16x16x32_bf16 v[136:139], v[48:51], v[96:99], v[136:139]
    ds_read_b128 v[112:115], v26 offset:832
    v_mfma_f32_16x16x32_bf16 v[144:147], v[44:47], v[96:99], v[144:147]
    ds_write_b128 v21, v[140:143] offset:0
    v_mfma_f32_16x16x32_bf16 v[148:151], v[40:43], v[96:99], v[148:151]
    ds_write_b32 v30, v80
    v_mfma_f32_16x16x32_bf16 v[152:155], v[36:39], v[96:99], v[152:155]
    s_waitcnt lgkmcnt(11)
    v_mfma_f32_16x16x32_bf16 v[156:159], v[64:67], v[100:103], 0
    ds_read_b64 v[6:7], v19 offset:3712
    s_waitcnt lgkmcnt(9)
    v_mfma_f32_16x16x32_bf16 v[124:127], v[68:71], v[104:107], v[124:127]
    ds_read_b64 v[8:9], v19 offset:3720
    v_mfma_f32_16x16x32_bf16 v[128:131], v[60:63], v[104:107], v[128:131]
    ds_read_b128 v[76:79], v20 offset:3712
    v_mfma_f32_16x16x32_bf16 v[132:135], v[56:59], v[104:107], v[132:135]
    ds_read_b64 v[10:11], v19 offset:896
I_c75:
    s_cbranch_execz I_h0
    v_mfma_f32_16x16x32_bf16 v[136:139], v[52:55], v[104:107], v[136:139]
    v_mfma_f32_16x16x32_bf16 v[144:147], v[48:51], v[104:107], v[144:147]
    v_mfma_f32_16x16x32_bf16 v[148:151], v[44:47], v[104:107], v[148:151]
    v_mfma_f32_16x16x32_bf16 v[152:155], v[40:43], v[104:107], v[152:155]
    s_waitcnt lgkmcnt(9)
    v_mfma_f32_16x16x32_bf16 v[156:159], v[72:75], v[108:111], v[156:159]
    ds_read_b64 v[12:13], v19 offset:904
    ds_read_b128 v[88:91], v26 offset:896
    s_waitcnt lgkmcnt(8)
    v_mfma_f32_16x16x32_bf16 v[124:127], v[2:5], v[112:115], v[124:127]
    ds_read_b64 v[14:15], v19 offset:3776
    v_mfma_f32_16x16x32_bf16 v[128:131], v[68:71], v[112:115], v[128:131]
    ds_read_b64 v[16:17], v19 offset:3784
    v_mfma_f32_16x16x32_bf16 v[132:135], v[60:63], v[112:115], v[132:135]
    ds_read_b128 v[92:95], v20 offset:3776
    v_mfma_f32_16x16x32_bf16 v[136:139], v[56:59], v[112:115], v[136:139]
    ds_read_b64 v[32:33], v19 offset:960
    v_mfma_f32_16x16x32_bf16 v[144:147], v[52:55], v[112:115], v[144:147]
    v_mfma_f32_16x16x32_bf16 v[148:151], v[48:51], v[112:115], v[148:151]
    v_mfma_f32_16x16x32_bf16 v[152:155], v[44:47], v[112:115], v[152:155]
    s_waitcnt lgkmcnt(7)
    v_mfma_f32_16x16x32_bf16 v[156:159], v[6:9], v[76:79], v[156:159]
    ds_read_b64 v[34:35], v19 offset:968
    ds_read_b128 v[96:99], v26 offset:960
    s_waitcnt lgkmcnt(6)
    v_mfma_f32_16x16x32_bf16 v[124:127], v[10:13], v[88:91], v[124:127]
    ds_read_b64 v[36:37], v19 offset:3840
    v_mfma_f32_16x16x32_bf16 v[128:131], v[2:5], v[88:91], v[128:131]
    ds_read_b64 v[38:39], v19 offset:3848
    v_mfma_f32_16x16x32_bf16 v[132:135], v[68:71], v[88:91], v[132:135]
    ds_read_b128 v[100:103], v20 offset:3840
    v_mfma_f32_16x16x32_bf16 v[136:139], v[60:63], v[88:91], v[136:139]
    ds_read_b128 v[104:107], v26 offset:1024
    v_mfma_f32_16x16x32_bf16 v[144:147], v[56:59], v[88:91], v[144:147]
    v_mfma_f32_16x16x32_bf16 v[148:151], v[52:55], v[88:91], v[148:151]
    ds_read_b64 v[64:65], v19 offset:3904
    v_mfma_f32_16x16x32_bf16 v[152:155], v[48:51], v[88:91], v[152:155]
    ds_read_b64 v[66:67], v19 offset:3912
    s_waitcnt lgkmcnt(9)
    v_mfma_f32_16x16x32_bf16 v[156:159], v[14:17], v[92:95], v[156:159]
    ds_read_b128 v[108:111], v20 offset:3904
    s_waitcnt lgkmcnt(7)
    v_mfma_f32_16x16x32_bf16 v[124:127], v[32:35], v[96:99], v[124:127]
    ds_read_b128 v[112:115], v26 offset:1088
    v_mfma_f32_16x16x32_bf16 v[128:131], v[10:13], v[96:99], v[128:131]
    v_mfma_f32_16x16x32_bf16 v[132:135], v[2:5], v[96:99], v[132:135]
    v_mfma_f32_16x16x32_bf16 v[136:139], v[68:71], v[96:99], v[136:139]
    ds_read_b64 v[40:41], v19 offset:3968
    v_mfma_f32_16x16x32_bf16 v[144:147], v[60:63], v[96:99], v[144:147]
    ds_read_b64 v[42:43], v19 offset:3976
    v_mfma_f32_16x16x32_bf16 v[148:151], v[56:59], v[96:99], v[148:151]
    ds_write_b128 v27, v[124:127] offset:2016
    v_mfma_f32_16x16x32_bf16 v[152:155], v[52:55], v[96:99], v[152:155]
    ds_read_b128 v[76:79], v20 offset:3968
    s_waitcnt lgkmcnt(9)
    v_mfma_f32_16x16x32_bf16 v[156:159], v[36:39], v[100:103], v[156:159]
    ds_read_b128 v[88:91], v26 offset:1152
    s_waitcnt lgkmcnt(9)
    v_mfma_f32_16x16x32_bf16 v[128:131], v[32:35], v[104:107], v[128:131]
    ds_read_b64 v[72:73], v19 offset:1024
I_c105:
    s_cbranch_execz I_c135
    v_mfma_f32_16x16x32_bf16 v[132:135], v[10:13], v[104:107], v[132:135]
    ds_read_b64 v[74:75], v19 offset:1032
    v_mfma_f32_16x16x32_bf16 v[136:139], v[2:5], v[104:107], v[136:139]
    ds_read_b128 v[92:95], v24 offset:1024
    v_mfma_f32_16x16x32_bf16 v[144:147], v[68:71], v[104:107], v[144:147]
    v_mfma_f32_16x16x32_bf16 v[148:151], v[60:63], v[104:107], v[148:151]
    v_mfma_f32_16x16x32_bf16 v[152:155], v[56:59], v[104:107], v[152:155]
    ds_write_b128 v27, v[128:131] offset:1872
    s_waitcnt lgkmcnt(10)
    v_mfma_f32_16x16x32_bf16 v[156:159], v[64:67], v[108:111], v[156:159]
    ds_read_b64 v[44:45], v19 offset:4032
    s_waitcnt lgkmcnt(10)
    v_mfma_f32_16x16x32_bf16 v[132:135], v[32:35], v[112:115], v[132:135]
    ds_read_b64 v[46:47], v19 offset:4040
    ds_read_b128 v[96:99], v20 offset:4032
    v_mfma_f32_16x16x32_bf16 v[136:139], v[10:13], v[112:115], v[136:139]
    v_mfma_f32_16x16x32_bf16 v[144:147], v[2:5], v[112:115], v[144:147]
    v_mfma_f32_16x16x32_bf16 v[148:151], v[68:71], v[112:115], v[148:151]
    v_mfma_f32_16x16x32_bf16 v[152:155], v[60:63], v[112:115], v[152:155]
    s_waitcnt lgkmcnt(8)
    v_mfma_f32_16x16x32_bf16 v[156:159], v[40:43], v[76:79], v[156:159]
    ds_read_b128 v[100:103], v26 offset:1216
    ds_read_b64 v[6:7], v19 offset:1088
    ds_read_b64 v[8:9], v19 offset:1096
    s_waitcnt lgkmcnt(10)
    v_mfma_f32_16x16x32_bf16 v[136:139], v[32:35], v[88:91], v[136:139]
    ds_read_b128 v[104:107], v24 offset:1088
    v_mfma_f32_16x16x32_bf16 v[144:147], v[10:13], v[88:91], v[144:147]
    ds_read_b128 v[108:111], v26 offset:1280
    v_mfma_f32_16x16x32_bf16 v[148:151], v[2:5], v[88:91], v[148:151]
    ds_write_b128 v27, v[132:135] offset:1728
    v_mfma_f32_16x16x32_bf16 v[152:155], v[68:71], v[88:91], v[152:155]
    s_waitcnt lgkmcnt(10)
    v_mfma_f32_16x16x32_bf16 v[124:127], v[72:75], v[92:95], 0
    ds_read_b64 v[48:49], v19 offset:1152
    ds_read_b64 v[50:51], v19 offset:1160
    s_waitcnt lgkmcnt(8)
    v_mfma_f32_16x16x32_bf16 v[156:159], v[44:47], v[96:99], v[156:159]
    ds_read_b128 v[112:115], v24 offset:1152
    ds_read_b128 v[76:79], v20 offset:3584
    s_waitcnt lgkmcnt(9)
    v_mfma_f32_16x16x32_bf16 v[144:147], v[32:35], v[100:103], v[144:147]
    ds_read_b128 v[88:91], v26 offset:1344
    v_mfma_f32_16x16x32_bf16 v[148:151], v[10:13], v[100:103], v[148:151]
    ds_read_b64 v[14:15], v19 offset:1216
    ds_read_b64 v[16:17], v19 offset:1224
    v_mfma_f32_16x16x32_bf16 v[152:155], v[2:5], v[100:103], v[152:155]
    ds_write_b128 v27, v[136:139] offset:1584
    s_waitcnt lgkmcnt(10)
    v_mfma_f32_16x16x32_bf16 v[124:127], v[6:9], v[104:107], v[124:127]
    ds_read_b128 v[92:95], v24 offset:1216
    v_mfma_f32_16x16x32_bf16 v[128:131], v[72:75], v[104:107], 0
    ds_read_b128 v[96:99], v20 offset:3648
    s_waitcnt lgkmcnt(11)
    v_mfma_f32_16x16x32_bf16 v[148:151], v[32:35], v[108:111], v[148:151]
    ds_write_b128 v27, v[144:147] offset:1440
    v_mfma_f32_16x16x32_bf16 v[152:155], v[10:13], v[108:111], v[152:155]
    s_waitcnt lgkmcnt(8)
    v_mfma_f32_16x16x32_bf16 v[124:127], v[48:51], v[112:115], v[124:127]
    ds_read_b64 v[52:53], v19 offset:1280
    ds_read_b64 v[54:55], v19 offset:1288
    ds_read_b128 v[100:103], v24 offset:1280
    v_mfma_f32_16x16x32_bf16 v[128:131], v[6:9], v[112:115], v[128:131]
    ds_read_b128 v[104:107], v20 offset:3712
    v_mfma_f32_16x16x32_bf16 v[132:135], v[72:75], v[112:115], 0
    s_waitcnt lgkmcnt(11)
    v_mfma_f32_16x16x32_bf16 v[140:143], v[72:75], v[76:79], 0
    ds_write_b128 v27, v[148:151] offset:1296
    s_waitcnt lgkmcnt(11)
    v_mfma_f32_16x16x32_bf16 v[152:155], v[32:35], v[88:91], v[152:155]
    ds_read_b64 v[36:37], v19 offset:1344
I_c135:
    s_cbranch_execz I_c165
    s_waitcnt lgkmcnt(8)
    v_mfma_f32_16x16x32_bf16 v[124:127], v[14:17], v[92:95], v[124:127]
    ds_read_b64 v[38:39], v19 offset:1352
    ds_read_b128 v[108:111], v24 offset:1344
    v_mfma_f32_16x16x32_bf16 v[128:131], v[48:51], v[92:95], v[128:131]
    ds_read_b128 v[112:115], v20 offset:3776
    v_mfma_f32_16x16x32_bf16 v[132:135], v[6:9], v[92:95], v[132:135]
    ds_read_b64 v[56:57], v19 offset:1408
    v_mfma_f32_16x16x32_bf16 v[136:139], v[72:75], v[92:95], 0
    s_waitcnt lgkmcnt(11)
    v_mfma_f32_16x16x32_bf16 v[140:143], v[6:9], v[96:99], v[140:143]
    ds_write_b128 v27, v[152:155] offset:1152
    s_waitcnt lgkmcnt(8)
    v_mfma_f32_16x16x32_bf16 v[124:127], v[52:55], v[100:103], v[124:127]
    ds_read_b64 v[58:59], v19 offset:1416
    ds_read_b128 v[76:79], v24 offset:1408
    v_mfma_f32_16x16x32_bf16 v[128:131], v[14:17], v[100:103], v[128:131]
    ds_write_b32 v30, v81
    v_mfma_f32_16x16x32_bf16 v[132:135], v[48:51], v[100:103], v[132:135]
    ds_read_b128 v[116:119], v21 offset:8064
    v_mfma_f32_16x16x32_bf16 v[136:139], v[6:9], v[100:103], v[136:139]
    v_mfma_f32_16x16x32_bf16 v[144:147], v[72:75], v[100:103], 0
    s_waitcnt lgkmcnt(11)
    v_mfma_f32_16x16x32_bf16 v[140:143], v[48:51], v[104:107], v[140:143]
    ds_read_b128 v[88:91], v20 offset:3840
    s_waitcnt lgkmcnt(8)
    v_mfma_f32_16x16x32_bf16 v[124:127], v[36:39], v[108:111], v[124:127]
    ds_read_b64 v[64:65], v19 offset:1472
    ds_read_b64 v[66:67], v19 offset:1480
    ds_read_b128 v[92:95], v24 offset:1472
    v_mfma_f32_16x16x32_bf16 v[128:131], v[52:55], v[108:111], v[128:131]
    s_waitcnt lgkmcnt(4)
    v_add_f32 v156, v156, v116
    v_add_f32 v157, v157, v117
    v_mfma_f32_16x16x32_bf16 v[132:135], v[14:17], v[108:111], v[132:135]
    v_add_f32 v158, v158, v118
    v_add_f32 v159, v159, v119
    v_mfma_f32_16x16x32_bf16 v[136:139], v[48:51], v[108:111], v[136:139]
    ds_write_b128 v21, v[156:159] offset:8064
    v_mfma_f32_16x16x32_bf16 v[144:147], v[6:9], v[108:111], v[144:147]
    ds_write_b32 v30, v82
    v_mfma_f32_16x16x32_bf16 v[140:143], v[14:17], v[112:115], v[140:143]
    ds_read_b128 v[96:99], v20 offset:3904
    v_mfma_f32_16x16x32_bf16 v[124:127], v[56:59], v[76:79], v[124:127]
    ds_read_b64 v[60:61], v19 offset:1536
    ds_read_b64 v[62:63], v19 offset:1544
    ds_read_b128 v[100:103], v24 offset:1536
    v_mfma_f32_16x16x32_bf16 v[128:131], v[36:39], v[76:79], v[128:131]
    ds_read_b128 v[104:107], v20 offset:3968
    v_mfma_f32_16x16x32_bf16 v[132:135], v[52:55], v[76:79], v[132:135]
    ds_read_b64 v[40:41], v19 offset:1600
    v_mfma_f32_16x16x32_bf16 v[136:139], v[14:17], v[76:79], v[136:139]
    v_mfma_f32_16x16x32_bf16 v[144:147], v[48:51], v[76:79], v[144:147]
    s_waitcnt lgkmcnt(11)
    v_mfma_f32_16x16x32_bf16 v[140:143], v[52:55], v[88:91], v[140:143]
    ds_read_b64 v[42:43], v19 offset:1608
    s_waitcnt lgkmcnt(9)
    v_mfma_f32_16x16x32_bf16 v[124:127], v[64:67], v[92:95], v[124:127]
    ds_read_b128 v[108:111], v24 offset:1600
    v_mfma_f32_16x16x32_bf16 v[128:131], v[56:59], v[92:95], v[128:131]
    ds_read_b128 v[112:115], v20 offset:4032
    v_mfma_f32_16x16x32_bf16 v[132:135], v[36:39], v[92:95], v[132:135]
    ds_read_b64 v[68:69], v19 offset:1664
    v_mfma_f32_16x16x32_bf16 v[136:139], v[52:55], v[92:95], v[136:139]
    v_mfma_f32_16x16x32_bf16 v[144:147], v[14:17], v[92:95], v[144:147]
    s_waitcnt lgkmcnt(9)
    v_mfma_f32_16x16x32_bf16 v[140:143], v[36:39], v[96:99], v[140:143]
    ds_read_b64 v[70:71], v19 offset:1672
    s_waitcnt lgkmcnt(7)
    v_mfma_f32_16x16x32_bf16 v[124:127], v[60:63], v[100:103], v[124:127]
    ds_read_b128 v[76:79], v24 offset:1664
I_c165:
    s_cbranch_execz I_h1
    v_mfma_f32_16x16x32_bf16 v[128:131], v[64:67], v[100:103], v[128:131]
    ds_read_b64 v[44:45], v19 offset:1728
    v_mfma_f32_16x16x32_bf16 v[132:135], v[56:59], v[100:103], v[132:135]
    ds_read_b128 v[120:123], v21 offset:2304
    v_mfma_f32_16x16x32_bf16 v[136:139], v[36:39], v[100:103], v[136:139]
    ds_read_b64 v[46:47], v19 offset:1736
    v_mfma_f32_16x16x32_bf16 v[144:147], v[52:55], v[100:103], v[144:147]
    ds_read_b128 v[88:91], v24 offset:1728
    s_waitcnt lgkmcnt(11)
    v_mfma_f32_16x16x32_bf16 v[140:143], v[56:59], v[104:107], v[140:143]
    ds_read_b64 v[2:3], v19 offset:1792
    s_waitcnt lgkmcnt(9)
    v_mfma_f32_16x16x32_bf16 v[124:127], v[40:43], v[108:111], v[124:127]
    ds_read_b64 v[4:5], v19 offset:1800
    v_mfma_f32_16x16x32_bf16 v[128:131], v[60:63], v[108:111], v[128:131]
    ds_read_b128 v[92:95], v24 offset:1792
    v_mfma_f32_16x16x32_bf16 v[132:135], v[64:67], v[108:111], v[132:135]
    v_mfma_f32_16x16x32_bf16 v[136:139], v[56:59], v[108:111], v[136:139]
    v_mfma_f32_16x16x32_bf16 v[144:147], v[36:39], v[108:111], v[144:147]
    ds_read_b64 v[10:11], v19 offset:1856
    s_waitcnt lgkmcnt(11)
    v_mfma_f32_16x16x32_bf16 v[140:143], v[64:67], v[112:115], v[140:143]
    ds_read_b64 v[12:13], v19 offset:1864
    s_waitcnt lgkmcnt(9)
    v_mfma_f32_16x16x32_bf16 v[124:127], v[68:71], v[76:79], v[124:127]
    ds_read_b128 v[96:99], v24 offset:1856
    v_mfma_f32_16x16x32_bf16 v[128:131], v[40:43], v[76:79], v[128:131]
    v_mfma_f32_16x16x32_bf16 v[132:135], v[60:63], v[76:79], v[132:135]
    v_mfma_f32_16x16x32_bf16 v[136:139], v[64:67], v[76:79], v[136:139]
    ds_read_b64 v[32:33], v19 offset:1920
    v_mfma_f32_16x16x32_bf16 v[144:147], v[56:59], v[76:79], v[144:147]
    s_waitcnt lgkmcnt(9)
    v_add_f32 v140, v140, v120
    v_add_f32 v141, v141, v121
    s_waitcnt lgkmcnt(7)
    v_mfma_f32_16x16x32_bf16 v[124:127], v[44:47], v[88:91], v[124:127]
    v_add_f32 v142, v142, v122
    v_add_f32 v143, v143, v123
    v_mfma_f32_16x16x32_bf16 v[128:131], v[68:71], v[88:91], v[128:131]
    ds_write_b128 v21, v[140:143] offset:2304
    v_mfma_f32_16x16x32_bf16 v[132:135], v[40:43], v[88:91], v[132:135]
    ds_write_b32 v30, v83
    v_mfma_f32_16x16x32_bf16 v[136:139], v[60:63], v[88:91], v[136:139]
    ds_read_b64 v[34:35], v19 offset:1928
    v_mfma_f32_16x16x32_bf16 v[144:147], v[64:67], v[88:91], v[144:147]
    ds_read_b128 v[100:103], v24 offset:1920
    s_waitcnt lgkmcnt(8)
    v_mfma_f32_16x16x32_bf16 v[124:127], v[2:5], v[92:95], v[124:127]
    ds_read_b64 v[72:73], v19 offset:1984
    v_mfma_f32_16x16x32_bf16 v[128:131], v[44:47], v[92:95], v[128:131]
    ds_read_b64 v[74:75], v19 offset:1992
    v_mfma_f32_16x16x32_bf16 v[132:135], v[68:71], v[92:95], v[132:135]
    ds_read_b128 v[104:107], v24 offset:1984
    v_mfma_f32_16x16x32_bf16 v[136:139], v[40:43], v[92:95], v[136:139]
    ds_read_b128 v[108:111], v24 offset:2048
    v_mfma_f32_16x16x32_bf16 v[144:147], v[60:63], v[92:95], v[144:147]
    s_waitcnt lgkmcnt(9)
    v_mfma_f32_16x16x32_bf16 v[124:127], v[10:13], v[96:99], v[124:127]
    v_mfma_f32_16x16x32_bf16 v[128:131], v[2:5], v[96:99], v[128:131]
    v_mfma_f32_16x16x32_bf16 v[132:135], v[44:47], v[96:99], v[132:135]
    ds_read_b128 v[112:115], v24 offset:2112
    v_mfma_f32_16x16x32_bf16 v[136:139], v[68:71], v[96:99], v[136:139]
I_c195:
    s_cbranch_execz I_c225
    v_mfma_f32_16x16x32_bf16 v[144:147], v[40:43], v[96:99], v[144:147]
    s_waitcnt lgkmcnt(5)
    v_mfma_f32_16x16x32_bf16 v[124:127], v[32:35], v[100:103], v[124:127]
    ds_read_b128 v[76:79], v24 offset:2176
    v_mfma_f32_16x16x32_bf16 v[128:131], v[10:13], v[100:103], v[128:131]
    v_mfma_f32_16x16x32_bf16 v[132:135], v[2:5], v[100:103], v[132:135]
    ds_read_b64 v[6:7], v19 offset:2048
    v_mfma_f32_16x16x32_bf16 v[136:139], v[44:47], v[100:103], v[136:139]
    ds_read_b64 v[8:9], v19 offset:2056
    v_mfma_f32_16x16x32_bf16 v[144:147], v[68:71], v[100:103], v[144:147]
    ds_read_b128 v[88:91], v22 offset:2048
    s_waitcnt lgkmcnt(6)
    v_mfma_f32_16x16x32_bf16 v[124:127], v[72:75], v[104:107], v[124:127]
    ds_read_b128 v[92:95], v24 offset:2240
    v_mfma_f32_16x16x32_bf16 v[128:131], v[32:35], v[104:107], v[128:131]
    ds_read_b64 v[48:49], v19 offset:2112
    v_mfma_f32_16x16x32_bf16 v[132:135], v[10:13], v[104:107], v[132:135]
    ds_read_b64 v[50:51], v19 offset:2120
    v_mfma_f32_16x16x32_bf16 v[136:139], v[2:5], v[104:107], v[136:139]
    ds_read_b128 v[96:99], v22 offset:2112
    v_mfma_f32_16x16x32_bf16 v[144:147], v[44:47], v[104:107], v[144:147]
    ds_read_b128 v[100:103], v20 offset:3584
    s_waitcnt lgkmcnt(10)
    v_mfma_f32_16x16x32_bf16 v[128:131], v[72:75], v[108:111], v[128:131]
    ds_write_b128 v28, v[124:127] offset:576
    v_mfma_f32_16x16x32_bf16 v[132:135], v[32:35], v[108:111], v[132:135]
    ds_read_b64 v[14:15], v19 offset:2176
    v_mfma_f32_16x16x32_bf16 v[136:139], v[10:13], v[108:111], v[136:139]
    v_mfma_f32_16x16x32_bf16 v[144:147], v[2:5], v[108:111], v[144:147]
    s_waitcnt lgkmcnt(11)
    v_mfma_f32_16x16x32_bf16 v[132:135], v[72:75], v[112:115], v[132:135]
    ds_read_b64 v[16:17], v19 offset:2184
    v_mfma_f32_16x16x32_bf16 v[136:139], v[32:35], v[112:115], v[136:139]
    ds_write_b128 v28, v[128:131] offset:432
    v_mfma_f32_16x16x32_bf16 v[144:147], v[10:13], v[112:115], v[144:147]
    s_waitcnt lgkmcnt(12)
    v_mfma_f32_16x16x32_bf16 v[136:139], v[72:75], v[76:79], v[136:139]
    v_mfma_f32_16x16x32_bf16 v[144:147], v[32:35], v[76:79], v[144:147]
    s_waitcnt lgkmcnt(9)
    v_mfma_f32_16x16x32_bf16 v[140:143], v[6:9], v[88:91], 0
    ds_read_b128 v[104:107], v22 offset:2176
    ds_read_b128 v[108:111], v20 offset:3648
    ds_read_b64 v[52:53], v19 offset:2240
    s_waitcnt lgkmcnt(11)
    v_mfma_f32_16x16x32_bf16 v[144:147], v[72:75], v[92:95], v[144:147]
    ds_read_b64 v[54:55], v19 offset:2248
    s_waitcnt lgkmcnt(9)
    v_mfma_f32_16x16x32_bf16 v[140:143], v[48:51], v[96:99], v[140:143]
    ds_read_b128 v[112:115], v22 offset:2240
    ds_read_b128 v[76:79], v20 offset:3712
    ds_read_b64 v[36:37], v19 offset:2304
    v_mfma_f32_16x16x32_bf16 v[148:151], v[6:9], v[96:99], 0
    ds_write_b128 v28, v[132:135] offset:288
    s_waitcnt lgkmcnt(12)
    v_mfma_f32_16x16x32_bf16 v[152:155], v[6:9], v[100:103], 0
    ds_write_b128 v28, v[136:139] offset:144
    s_waitcnt lgkmcnt(8)
    v_mfma_f32_16x16x32_bf16 v[140:143], v[14:17], v[104:107], v[140:143]
    ds_read_b64 v[38:39], v19 offset:2312
    ds_read_b128 v[88:91], v22 offset:2304
    ds_read_b128 v[92:95], v20 offset:3776
    v_mfma_f32_16x16x32_bf16 v[148:151], v[48:51], v[104:107], v[148:151]
    ds_read_b64 v[56:57], v19 offset:2368
    v_mfma_f32_16x16x32_bf16 v[124:127], v[6:9], v[104:107], 0
    ds_write_b128 v28, v[144:147] offset:0
    s_waitcnt lgkmcnt(12)
    v_mfma_f32_16x16x32_bf16 v[152:155], v[48:51], v[108:111], v[152:155]
    ds_write_b32 v30, v84
    s_waitcnt lgkmcnt(10)
    v_mfma_f32_16x16x32_bf16 v[140:143], v[52:55], v[112:115], v[140:143]
    ds_read_b64 v[58:59], v19 offset:2376
    ds_read_b128 v[96:99], v22 offset:2368
I_c225:
    s_cbranch_execz I_c255
    v_mfma_f32_16x16x32_bf16 v[148:151], v[14:17], v[112:115], v[148:151]
    v_mfma_f32_16x16x32_bf16 v[124:127], v[48:51], v[112:115], v[124:127]
    s_waitcnt lgkmcnt(11)
    v_mfma_f32_16x16x32_bf16 v[152:155], v[14:17], v[76:79], v[152:155]
    ds_read_b128 v[100:103], v20 offset:3840
    s_waitcnt lgkmcnt(7)
    v_mfma_f32_16x16x32_bf16 v[140:143], v[36:39], v[88:91], v[140:143]
    ds_read_b64 v[64:65], v19 offset:2432
    ds_read_b64 v[66:67], v19 offset:2440
    ds_read_b128 v[104:107], v22 offset:2432
    v_mfma_f32_16x16x32_bf16 v[148:151], v[52:55], v[88:91], v[148:151]
    ds_read_b128 v[108:111], v20 offset:3904
    ds_read_b64 v[60:61], v19 offset:2496
    v_mfma_f32_16x16x32_bf16 v[124:127], v[14:17], v[88:91], v[124:127]
    s_waitcnt lgkmcnt(11)
    v_mfma_f32_16x16x32_bf16 v[152:155], v[52:55], v[92:95], v[152:155]
    ds_read_b64 v[62:63], v19 offset:2504
    s_waitcnt lgkmcnt(7)
    v_mfma_f32_16x16x32_bf16 v[140:143], v[56:59], v[96:99], v[140:143]
    ds_read_b128 v[112:115], v22 offset:2496
    ds_read_b128 v[76:79], v20 offset:3968
    v_mfma_f32_16x16x32_bf16 v[148:151], v[36:39], v[96:99], v[148:151]
    ds_read_b64 v[40:41], v19 offset:2560
    ds_read_b64 v[42:43], v19 offset:2568
    ds_read_b128 v[88:91], v22 offset:2560
    v_mfma_f32_16x16x32_bf16 v[124:127], v[52:55], v[96:99], v[124:127]
    s_waitcnt lgkmcnt(11)
    v_mfma_f32_16x16x32_bf16 v[152:155], v[36:39], v[100:103], v[152:155]
    ds_read_b128 v[92:95], v20 offset:4032
    s_waitcnt lgkmcnt(9)
    v_mfma_f32_16x16x32_bf16 v[140:143], v[64:67], v[104:107], v[140:143]
    ds_read_b64 v[68:69], v19 offset:2624
    v_mfma_f32_16x16x32_bf16 v[148:151], v[56:59], v[104:107], v[148:151]
    ds_read_b64 v[70:71], v19 offset:2632
    ds_read_b128 v[96:99], v22 offset:2624
    v_mfma_f32_16x16x32_bf16 v[124:127], v[36:39], v[104:107], v[124:127]
    ds_read_b128 v[116:119], v21 offset:4608
    s_waitcnt lgkmcnt(12)
    v_mfma_f32_16x16x32_bf16 v[152:155], v[56:59], v[108:111], v[152:155]
    s_waitcnt lgkmcnt(9)
    v_mfma_f32_16x16x32_bf16 v[140:143], v[60:63], v[112:115], v[140:143]
    ds_read_b64 v[44:45], v19 offset:2688
    ds_read_b64 v[46:47], v19 offset:2696
    ds_read_b128 v[100:103], v22 offset:2688
    v_mfma_f32_16x16x32_bf16 v[148:151], v[64:67], v[112:115], v[148:151]
    v_mfma_f32_16x16x32_bf16 v[124:127], v[56:59], v[112:115], v[124:127]
    s_waitcnt lgkmcnt(11)
    v_mfma_f32_16x16x32_bf16 v[152:155], v[64:67], v[76:79], v[152:155]
    ds_read_b64 v[2:3], v19 offset:2752
    s_waitcnt lgkmcnt(9)
    v_mfma_f32_16x16x32_bf16 v[140:143], v[40:43], v[88:91], v[140:143]
    ds_read_b64 v[4:5], v19 offset:2760
    ds_read_b128 v[104:107], v22 offset:2752
    v_mfma_f32_16x16x32_bf16 v[148:151], v[60:63], v[88:91], v[148:151]
    ds_read_b64 v[10:11], v19 offset:2816
    v_mfma_f32_16x16x32_bf16 v[124:127], v[64:67], v[88:91], v[124:127]
    s_waitcnt lgkmcnt(11)
    v_mfma_f32_16x16x32_bf16 v[152:155], v[60:63], v[92:95], v[152:155]
I_conv2:
    s_cbranch_execz B_3
    ds_read_b64 v[12:13], v19 offset:2824
    s_waitcnt lgkmcnt(9)
    v_mfma_f32_16x16x32_bf16 v[140:143], v[68:71], v[96:99], v[140:143]
    ds_read_b128 v[108:111], v22 offset:2816
    v_mfma_f32_16x16x32_bf16 v[148:151], v[40:43], v[96:99], v[148:151]
    ds_read_b64 v[32:33], v19 offset:2880
    v_mfma_f32_16x16x32_bf16 v[124:127], v[60:63], v[96:99], v[124:127]
    ds_read_b64 v[34:35], v19 offset:2888
    s_waitcnt lgkmcnt(8)
    v_mfma_f32_16x16x32_bf16 v[140:143], v[44:47], v[100:103], v[140:143]
    ds_read_b128 v[112:115], v22 offset:2880
    v_mfma_f32_16x16x32_bf16 v[148:151], v[68:71], v[100:103], v[148:151]
    v_add_f32 v152, v152, v116
    v_add_f32 v153, v153, v117
    v_mfma_f32_16x16x32_bf16 v[124:127], v[40:43], v[100:103], v[124:127]
    ds_read_b64 v[72:73], v19 offset:2944
    ds_read_b64 v[74:75], v19 offset:2952
    ds_read_b128 v[76:79], v22 offset:2944
    s_waitcnt lgkmcnt(9)
    v_mfma_f32_16x16x32_bf16 v[140:143], v[2:5], v[104:107], v[140:143]
    v_add_f32 v154, v154, v118
    v_add_f32 v155, v155, v119
I_c255:
    s_cbranch_execz I_h2
    v_mfma_f32_16x16x32_bf16 v[148:151], v[44:47], v[104:107], v[148:151]
    ds_write_b128 v21, v[152:155] offset:4608
    v_mfma_f32_16x16x32_bf16 v[124:127], v[68:71], v[104:107], v[124:127]
    ds_read_b64 v[6:7], v19 offset:3008
    ds_read_b64 v[8:9], v19 offset:3016
    s_waitcnt lgkmcnt(9)
    v_mfma_f32_16x16x32_bf16 v[140:143], v[10:13], v[108:111], v[140:143]
    ds_read_b128 v[88:91], v22 offset:3008
    ds_write_b32 v30, v85
    v_mfma_f32_16x16x32_bf16 v[148:151], v[2:5], v[108:111], v[148:151]
    ds_read_b64 v[48:49], v19 offset:3072
    v_mfma_f32_16x16x32_bf16 v[124:127], v[44:47], v[108:111], v[124:127]
    s_waitcnt lgkmcnt(9)
    v_mfma_f32_16x16x32_bf16 v[140:143], v[32:35], v[112:115], v[140:143]
    ds_read_b64 v[50:51], v19 offset:3080
    ds_read_b128 v[92:95], v22 offset:3072
    v_mfma_f32_16x16x32_bf16 v[148:151], v[10:13], v[112:115], v[148:151]
    ds_read_b64 v[14:15], v19 offset:3136
    v_mfma_f32_16x16x32_bf16 v[124:127], v[2:5], v[112:115], v[124:127]
    s_waitcnt lgkmcnt(9)
    v_mfma_f32_16x16x32_bf16 v[140:143], v[72:75], v[76:79], v[140:143]
    ds_read_b64 v[16:17], v19 offset:3144
    ds_read_b128 v[96:99], v22 offset:3136
    v_mfma_f32_16x16x32_bf16 v[148:151], v[32:35], v[76:79], v[148:151]
    ds_read_b64 v[52:53], v19 offset:3200
    v_mfma_f32_16x16x32_bf16 v[124:127], v[10:13], v[76:79], v[124:127]
    s_waitcnt lgkmcnt(8)
    v_mfma_f32_16x16x32_bf16 v[140:143], v[6:9], v[88:91], v[140:143]
    ds_read_b64 v[54:55], v19 offset:3208
    ds_read_b128 v[100:103], v22 offset:3200
    v_mfma_f32_16x16x32_bf16 v[148:151], v[72:75], v[88:91], v[148:151]
    ds_read_b64 v[36:37], v19 offset:3264
    v_mfma_f32_16x16x32_bf16 v[124:127], v[32:35], v[88:91], v[124:127]
    ds_read_b64 v[38:39], v19 offset:3272
    s_waitcnt lgkmcnt(8)
    v_mfma_f32_16x16x32_bf16 v[140:143], v[48:51], v[92:95], v[140:143]
    ds_read_b128 v[104:107], v22 offset:3264
    v_mfma_f32_16x16x32_bf16 v[148:151], v[6:9], v[92:95], v[148:151]
    ds_read_b64 v[56:57], v19 offset:3328
    v_mfma_f32_16x16x32_bf16 v[124:127], v[72:75], v[92:95], v[124:127]
    ds_read_b64 v[58:59], v19 offset:3336
    ds_read_b128 v[108:111], v22 offset:3328
    s_waitcnt lgkmcnt(9)
    v_mfma_f32_16x16x32_bf16 v[140:143], v[14:17], v[96:99], v[140:143]
    ds_read_b64 v[64:65], v19 offset:3392
    v_mfma_f32_16x16x32_bf16 v[148:151], v[48:51], v[96:99], v[148:151]
    ds_read_b64 v[66:67], v19 offset:3400
    v_mfma_f32_16x16x32_bf16 v[124:127], v[6:9], v[96:99], v[124:127]
    ds_read_b128 v[112:115], v22 offset:3392
    s_waitcnt lgkmcnt(9)
    v_mfma_f32_16x16x32_bf16 v[140:143], v[52:55], v[100:103], v[140:143]
    ds_read_b64 v[60:61], v19 offset:3456
    v_mfma_f32_16x16x32_bf16 v[148:151], v[14:17], v[100:103], v[148:151]
    ds_read_b64 v[62:63], v19 offset:3464
    v_mfma_f32_16x16x32_bf16 v[124:127], v[48:51], v[100:103], v[124:127]
    ds_read_b128 v[76:79], v22 offset:3456
    s_waitcnt lgkmcnt(9)
    v_mfma_f32_16x16x32_bf16 v[140:143], v[36:39], v[104:107], v[140:143]
    ds_read_b64 v[40:41], v19 offset:3520
    v_mfma_f32_16x16x32_bf16 v[148:151], v[52:55], v[104:107], v[148:151]
    ds_read_b64 v[42:43], v19 offset:3528
    v_mfma_f32_16x16x32_bf16 v[124:127], v[14:17], v[104:107], v[124:127]
    ds_read_b128 v[88:91], v22 offset:3520
    s_waitcnt lgkmcnt(9)
    v_mfma_f32_16x16x32_bf16 v[140:143], v[56:59], v[108:111], v[140:143]
    ds_read_b128 v[92:95], v22 offset:3584
    v_mfma_f32_16x16x32_bf16 v[148:151], v[36:39], v[108:111], v[148:151]
    ds_read_b128 v[96:99], v22 offset:3648
    v_mfma_f32_16x16x32_bf16 v[124:127], v[52:55], v[108:111], v[124:127]
    s_waitcnt lgkmcnt(8)
    v_mfma_f32_16x16x32_bf16 v[140:143], v[64:67], v[112:115], v[140:143]
I_c285:
    s_cbranch_execz B_walk
    v_mfma_f32_16x16x32_bf16 v[148:151], v[56:59], v[112:115], v[148:151]
    v_mfma_f32_16x16x32_bf16 v[124:127], v[36:39], v[112:115], v[124:127]
    s_waitcnt lgkmcnt(5)
    v_mfma_f32_16x16x32_bf16 v[140:143], v[60:63], v[76:79], v[140:143]
    v_mfma_f32_16x16x32_bf16 v[148:151], v[64:67], v[76:79], v[148:151]
    v_mfma_f32_16x16x32_bf16 v[124:127], v[56:59], v[76:79], v[124:127]
    s_waitcnt lgkmcnt(2)
    v_mfma_f32_16x16x32_bf16 v[140:143], v[40:43], v[88:91], v[140:143]
    v_mfma_f32_16x16x32_bf16 v[148:151], v[60:63], v[88:91], v[148:151]
    v_mfma_f32_16x16x32_bf16 v[124:127], v[64:67], v[88:91], v[124:127]
    s_waitcnt lgkmcnt(1)
    v_mfma_f32_16x16x32_bf16 v[148:151], v[40:43], v[92:95], v[148:151]
    v_mfma_f32_16x16x32_bf16 v[124:127], v[60:63], v[92:95], v[124:127]
    s_waitcnt lgkmcnt(0)
    v_mfma_f32_16x16x32_bf16 v[124:127], v[40:43], v[96:99], v[124:127]
    s_nop 0
    ds_write_b128 v29, v[140:143] offset:288
    s_nop 2
    ds_write_b128 v29, v[148:151] offset:144
    s_nop 1
    ds_write_b128 v29, v[124:127] offset:0
    ds_write_b32 v30, v86
    s_endpgm
F_help:
I_h0:
    s_cbranch_execz B_walk
    s_cmp_lg_u32 s44, 11
    s_cbranch_scc1 L_noseen
    s_lshl_b32 s47, s2, 7
    s_add_u32 s47, s47, 8421376
    v_mov_b32 v2, s47
    v_mov_b32 v3, s72
    s_mov_b64 exec, 1
    global_store_dword v2, v3, s[40:41] sc1
    s_mov_b64 exec, -1
L_noseen:
    global_load_dwordx4 v[2:5], v30, s[40:41] sc1
    s_sub_u32 s57, s44, 4
    s_lshl_b32 s57, s57, 2
    v_and_b32 v6, 4, v1
    v_cmp_eq_u32 s[64:65], 0, v6
    s_lshr_b32 s18, 0x32252421, s57
    s_and_b32 s18, s18, 15
    s_lshr_b32 s47, 0x0, s57
    s_and_b32 s47, s47, 15
    v_mov_b32 v6, s18
    v_mov_b32 v10, s47
    v_cndmask_b32 v10, v10, v6, s[64:65]
    s_lshr_b32 s47, 0x10000, s57
    s_and_b32 s47, s47, 15
    s_cmp_eq_u32 s47, 1
    s_cselect_b32 s56, 120448, 0
    s_cselect_b32 s58, 5760, 0
    s_cmp_eq_u32 s47, 2
    s_cselect_b32 s56, 141184, s56
    s_cselect_b32 s58, 3456, s58
    s_cmp_eq_u32 s47, 0
    s_cselect_b32 s58, 9216, s58
    v_add_u32 v14, s56, v27
    v_add_u32 v15, s58, v14
    v_add_u32 v16, s58, v15
    v_add_u32 v17, s58, v16
    s_lshr_b32 s19, 0x55565000, s57
    s_and_b32 s19, s19, 15
    s_lshr_b32 s47, 0x0, s57
    s_and_b32 s47, s47, 15
    v_mov_b32 v6, s19
    v_mov_b32 v11, s47
    v_cndmask_b32 v11, v11, v6, s[64:65]
    s_lshr_b32 s47, 0x11101000, s57
    s_and_b32 s47, s47, 15
    s_cmp_eq_u32 s47, 1
    s_cselect_b32 s56, 120448, 0
    s_cselect_b32 s58, 5760, 0
    s_cmp_eq_u32 s47, 2
    s_cselect_b32 s56, 141184, s56
    s_cselect_b32 s58, 3456, s58
    s_cmp_eq_u32 s47, 0
    s_cselect_b32 s58, 9216, s58
    v_add_u32 v20, s56, v27
    v_add_u32 v21, s58, v20
    v_add_u32 v22, s58, v21
    v_add_u32 v23, s58, v22
    s_lshr_b32 s20, 0x77700000, s57
    s_and_b32 s20, s20, 15
    s_lshr_b32 s47, 0x0, s57
    s_and_b32 s47, s47, 15
    v_mov_b32 v6, s20
    v_mov_b32 v12, s47
    v_cndmask_b32 v12, v12, v6, s[64:65]
    s_lshr_b32 s47, 0x22200000, s57
    s_and_b32 s47, s47, 15
    s_cmp_eq_u32 s47, 1
    s_cselect_b32 s56, 120448, 0
    s_cselect_b32 s58, 5760, 0
    s_cmp_eq_u32 s47, 2
    s_cselect_b32 s56, 141184, s56
    s_cselect_b32 s58, 3456, s58
    s_cmp_eq_u32 s47, 0
    s_cselect_b32 s58, 9216, s58
    v_add_u32 v32, s56, v27
    v_add_u32 v33, s58, v32
    v_add_u32 v34, s58, v33
    v_add_u32 v35, s58, v34
    s_lshl_b32 s47, s45, 1
    v_add_u32 v29, s47, v29
    s_waitcnt lgkmcnt(0)
    s_barrier
    s_cmp_lg_u32 s43, 0
    s_cbranch_scc1 L_nowb
    s_cmp_lg_u32 s44, 11
    s_cbranch_scc1 L_nowb
    buffer_wbl2 sc1
L_nowb:
    ds_read_b64 v[6:7], v28 offset:0
    ds_read_b64 v[24:25], v28 offset:5120
    ds_read_b64 v[36:37], v28 offset:10240
    ds_read_b64 v[38:39], v28 offset:15360
    s_waitcnt lgkmcnt(3)
    v_lshlrev_b32 v43, 16, v6
    v_and_b32 v42, s46, v6
    v_lshlrev_b32 v41, 16, v7
    v_and_b32 v40, s46, v7
    s_waitcnt lgkmcnt(2)
    v_lshlrev_b32 v47, 16, v24
    v_and_b32 v46, s46, v24
    v_lshlrev_b32 v45, 16, v25
    v_and_b32 v44, s46, v25
    s_waitcnt lgkmcnt(1)
    v_lshlrev_b32 v51, 16, v36
    v_and_b32 v50, s46, v36
    v_lshlrev_b32 v49, 16, v37
    v_and_b32 v48, s46, v37
    s_waitcnt lgkmcnt(0)
    v_lshlrev_b32 v55, 16, v38
    v_and_b32 v54, s46, v38
    v_lshlrev_b32 v53, 16, v39
    v_and_b32 v52, s46, v39
    v_mul_f32 v36, s66, v40
    v_mul_f32 v48, s68, v48
    v_mul_f32 v37, s66, v41
    v_mul_f32 v49, s68, v49
    v_mul_f32 v38, s66, v42
    v_mul_f32 v50, s68, v50
    v_mul_f32 v39, s66, v43
    v_mul_f32 v51, s68, v51
    v_mul_f32 v56, s67, v44
    v_mul_f32 v52, s69, v52
    v_mul_f32 v57, s67, v45
    v_mul_f32 v53, s69, v53
    v_mul_f32 v58, s67, v46
    v_mul_f32 v54, s69, v54
    v_mul_f32 v59, s67, v47
    v_mul_f32 v55, s69, v55
I_h1:
    s_cbranch_execz B_walk
    s_mov_b32 s73, 0
L_poll_gate:
    s_waitcnt vmcnt(0)
    v_cmp_ne_u32 vcc, s72, v3
    v_cmp_ne_u32 s[64:65], s72, v5
    s_nop 0
    s_or_b64 vcc, vcc, s[64:65]
    s_cbranch_vccz L_polled_gate
    global_load_dwordx4 v[2:5], v30, s[40:41] sc1
    s_add_u32 s73, s73, 1
    s_cmp_lt_u32 s73, 65536
    s_cbranch_scc1 L_poll_gate
    s_waitcnt vmcnt(0)
L_polled_gate:
    v_lshlrev_b32 v60, 16, v2
    v_and_b32 v61, s46, v2
    v_lshlrev_b32 v62, 16, v4
    v_and_b32 v63, s46, v4
    v_sub_f32 v64, 1.0, v60
    v_sub_f32 v65, 1.0, v61
    v_sub_f32 v66, 1.0, v62
    v_sub_f32 v67, 1.0, v63
    v_mul_f32 v40, v40, v64
    v_mul_f32 v36, v36, v60
    v_mul_f32 v41, v41, v65
    v_mul_f32 v37, v37, v61
    v_mul_f32 v42, v42, v66
    v_mul_f32 v38, v38, v62
    v_mul_f32 v43, v43, v67
    v_mul_f32 v39, v39, v63
    v_fmac_f32 v36, v48, v40
    v_fmac_f32 v37, v49, v41
    v_fmac_f32 v38, v50, v42
    v_fmac_f32 v39, v51, v43
    v_mul_f32 v44, v44, v64
    v_mul_f32 v56, v56, v60
    v_mul_f32 v45, v45, v65
    v_mul_f32 v57, v57, v61
    v_mul_f32 v46, v46, v66
    v_mul_f32 v58, v58, v62
    v_mul_f32 v47, v47, v67
    v_mul_f32 v59, v59, v63
    v_fmac_f32 v56, v52, v44
    v_fmac_f32 v57, v53, v45
    v_fmac_f32 v58, v54, v46
    v_fmac_f32 v59, v55, v47
    s_cmp_lg_u32 s45, 0
    s_cbranch_scc1 L_noepoch
    s_cmp_lt_u32 s44, 8
    s_cbranch_scc1 L_noepoch
    v_subrev_u32 v2, 512, v0
    v_lshlrev_b32 v2, 7, v2
    v_add_u32 v2, 8421376, v2
    global_load_dword v3, v2, s[40:41] sc1
    s_mov_b32 s73, 0
L_poll_all:
    s_waitcnt vmcnt(0)
    v_cmp_ne_u32 vcc, s72, v3
    s_cbranch_vccz L_polled_all
    global_load_dword v3, v2, s[40:41] sc1
    s_add_u32 s73, s73, 1
    s_cmp_lt_u32 s73, 65536
    s_cbranch_scc1 L_poll_all
    s_waitcnt vmcnt(0)
L_polled_all:
    v_mov_b32 v4, 163500
    v_mov_b32 v5, 1
    s_mov_b64 exec, 1
    ds_add_rtn_u32 v5, v4, v5
    s_waitcnt lgkmcnt(0)
    v_readfirstlane_b32 s56, v5
    v_mov_b32 v2, 8486912
    v_mov_b32 v3, s72
    s_cmp_lg_u32 s56, 3
    s_cbranch_scc1 L_noepoch1
    global_store_dword v2, v3, s[40:41]
L_noepoch1:
    s_mov_b64 exec, -1
L_noepoch:
I_h2:
    s_cbranch_execz B_walk
    s_mov_b32 s73, 0
L_lvl_0:
    ds_read_b32 v2, v31
    s_add_u32 s73, s73, 1
    s_waitcnt lgkmcnt(0)
    v_cmp_gt_u32 vcc, v10, v2
    s_cbranch_vccz L_lvl_0_ok
    s_sleep 1
    s_cmp_lt_u32 s73, 1048576
    s_cbranch_scc1 L_lvl_0
L_lvl_0_ok:
    ds_read_b128 v[2:5], v14
    ds_read_b128 v[52:55], v16
    ds_read_b128 v[48:51], v15
    ds_read_b128 v[68:71], v17
    s_waitcnt lgkmcnt(3)
    v_fmac_f32 v36, v2, v60
    v_fmac_f32 v37, v3, v61
    v_fmac_f32 v38, v4, v62
    v_fmac_f32 v39, v5, v63
    s_waitcnt lgkmcnt(2)
    v_fmac_f32 v36, v52, v40
    v_fmac_f32 v37, v53, v41
    v_fmac_f32 v38, v54, v42
    v_fmac_f32 v39, v55, v43
    s_waitcnt lgkmcnt(1)
    v_fmac_f32 v56, v48, v60
    v_fmac_f32 v57, v49, v61
    v_fmac_f32 v58, v50, v62
    v_fmac_f32 v59, v51, v63
    s_waitcnt lgkmcnt(0)
    v_fmac_f32 v56, v68, v44
    v_fmac_f32 v57, v69, v45
    v_fmac_f32 v58, v70, v46
    v_fmac_f32 v59, v71, v47
    s_cmp_eq_u32 s19, 0
    s_cbranch_scc1 L_summed
    s_mov_b32 s73, 0
L_lvl_1:
    ds_read_b32 v2, v31
    s_add_u32 s73, s73, 1
    s_waitcnt lgkmcnt(0)
    v_cmp_gt_u32 vcc, v11, v2
    s_cbranch_vccz L_lvl_1_ok
    s_sleep 1
    s_cmp_lt_u32 s73, 1048576
    s_cbranch_scc1 L_lvl_1
L_lvl_1_ok:
    ds_read_b128 v[2:5], v20
    ds_read_b128 v[52:55], v22
    ds_read_b128 v[48:51], v21
    ds_read_b128 v[68:71], v23
    s_waitcnt lgkmcnt(3)
    v_fmac_f32 v36, v2, v60
    v_fmac_f32 v37, v3, v61
    v_fmac_f32 v38, v4, v62
    v_fmac_f32 v39, v5, v63
    s_waitcnt lgkmcnt(2)
    v_fmac_f32 v36, v52, v40
    v_fmac_f32 v37, v53, v41
    v_fmac_f32 v38, v54, v42
    v_fmac_f32 v39, v55, v43
    s_waitcnt lgkmcnt(1)
    v_fmac_f32 v56, v48, v60
    v_fmac_f32 v57, v49, v61
    v_fmac_f32 v58, v50, v62
    v_fmac_f32 v59, v51, v63
    s_waitcnt lgkmcnt(0)
    v_fmac_f32 v56, v68, v44
    v_fmac_f32 v57, v69, v45
    v_fmac_f32 v58, v70, v46
    v_fmac_f32 v59, v71, v47
    s_cmp_eq_u32 s20, 0
    s_cbranch_scc1 L_summed
    s_mov_b32 s73, 0
L_lvl_2:
    ds_read_b32 v2, v31
    s_add_u32 s73, s73, 1
    s_waitcnt lgkmcnt(0)
    v_cmp_gt_u32 vcc, v12, v2
    s_cbranch_vccz L_lvl_2_ok
    s_sleep 1
    s_cmp_lt_u32 s73, 1048576
    s_cbranch_scc1 L_lvl_2
L_lvl_2_ok:
    ds_read_b128 v[2:5], v32
    ds_read_b128 v[52:55], v34
    ds_read_b128 v[48:51], v33
    ds_read_b128 v[68:71], v35
    s_waitcnt lgkmcnt(3)
    v_fmac_f32 v36, v2, v60
    v_fmac_f32 v37, v3, v61
    v_fmac_f32 v38, v4, v62
    v_fmac_f32 v39, v5, v63
    s_waitcnt lgkmcnt(2)
    v_fmac_f32 v36, v52, v40
    v_fmac_f32 v37, v53, v41
    v_fmac_f32 v38, v54, v42
    v_fmac_f32 v39, v55, v43
    s_waitcnt lgkmcnt(1)
    v_fmac_f32 v56, v48, v60
    v_fmac_f32 v57, v49, v61
    v_fmac_f32 v58, v50, v62
    v_fmac_f32 v59, v51, v63
    s_waitcnt lgkmcnt(0)
    v_fmac_f32 v56, v68, v44
    v_fmac_f32 v57, v69, v45
    v_fmac_f32 v58, v70, v46
    v_fmac_f32 v59, v71, v47
L_summed:
    v_cvt_pk_bf16_f32 v2, v36, v56
    global_store_dword v29, v2, s[36:37] offset:0
    v_cvt_pk_bf16_f32 v3, v37, v57
    global_store_dword v29, v3, s[36:37] offset:896
    v_cvt_pk_bf16_f32 v4, v38, v58
    global_store_dword v29, v4, s[36:37] offset:1792
    v_cvt_pk_bf16_f32 v5, v39, v59
    global_store_dword v29, v5, s[36:37] offset:2688
    s_endpgm
F_help_end:
F_gate:
    s_waitcnt vmcnt(0) lgkmcnt(0)
    s_nop 11
    s_setprio 0
    s_cmp_ge_u32 s44, 8
    s_cbranch_scc1 F_exit
    s_mov_b32 s48, s4
    s_mov_b32 s49, s5
    s_mov_b32 s50, 1835008
    s_mov_b32 s51, 0x20000
    s_mov_b32 s52, s34
    s_mov_b32 s53, s35
    s_mov_b32 s54, 896
    s_mov_b32 s55, 0x20000
    v_lshlrev_b32 v2, 4, v1
    buffer_load_dwordx4 v[4:7], v2, s[52:55], 0 offen
    s_lshl_b32 s57, s43, 3
    s_add_u32 s57, s57, s44
    s_mul_i32 s56, s57, 7168
    v_add_u32 v2, s56, v2
    v_add_u32 v3, 3584, v2
    buffer_load_dwordx4 v[8:11], v2, s[48:51], 0 offen offset:0 nt
    buffer_load_dwordx4 v[12:15], v2, s[48:51], 0 offen offset:896 nt
    buffer_load_dwordx4 v[16:19], v2, s[48:51], 0 offen offset:1792 nt
    buffer_load_dwordx4 v[20:23], v2, s[48:51], 0 offen offset:2688 nt
    buffer_load_dwordx4 v[24:27], v3, s[48:51], 0 offen offset:0 nt
    buffer_load_dwordx4 v[28:31], v3, s[48:51], 0 offen offset:896 nt
    buffer_load_dwordx4 v[32:35], v3, s[48:51], 0 offen offset:1792 nt
    buffer_load_dwordx4 v[36:39], v3, s[48:51], 0 offen offset:2688 nt
    s_cmp_lg_u32 s44, 0
    s_cbranch_scc1 L_noseen_g
    s_lshl_b32 s47, s2, 7
    s_add_u32 s47, s47, 8421376
    v_mov_b32 v40, s47
    v_mov_b32 v41, s72
    s_mov_b64 exec, 1
    global_store_dword v40, v41, s[40:41] sc1
    s_mov_b64 exec, -1
L_noseen_g:
    s_mov_b32 s70, 0x05040100
    s_waitcnt vmcnt(0)
    v_dot2_f32_bf16 v40, v8, v4, 0
    v_dot2_f32_bf16 v41, v12, v4, 0
    v_dot2_f32_bf16 v42, v16, v4, 0
    v_dot2_f32_bf16 v43, v20, v4, 0
    v_dot2_f32_bf16 v44, v24, v4, 0
    v_dot2_f32_bf16 v45, v28, v4, 0
    v_dot2_f32_bf16 v46, v32, v4, 0
    v_dot2_f32_bf16 v47, v36, v4, 0
    v_dot2_f32_bf16 v40, v9, v5, v40
    v_dot2_f32_bf16 v41, v13, v5, v41
    v_dot2_f32_bf16 v42, v17, v5, v42
    v_dot2_f32_bf16 v43, v21, v5, v43
    v_dot2_f32_bf16 v44, v25, v5, v44
    v_dot2_f32_bf16 v45, v29, v5, v45
    v_dot2_f32_bf16 v46, v33, v5, v46
    v_dot2_f32_bf16 v47, v37, v5, v47
    v_dot2_f32_bf16 v40, v10, v6, v40
    v_dot2_f32_bf16 v41, v14, v6, v41
    v_dot2_f32_bf16 v42, v18, v6, v42
    v_dot2_f32_bf16 v43, v22, v6, v43
    v_dot2_f32_bf16 v44, v26, v6, v44
    v_dot2_f32_bf16 v45, v30, v6, v45
    v_dot2_f32_bf16 v46, v34, v6, v46
    v_dot2_f32_bf16 v47, v38, v6, v47
    v_dot2_f32_bf16 v40, v11, v7, v40
    v_dot2_f32_bf16 v41, v15, v7, v41
    v_dot2_f32_bf16 v42, v19, v7, v42
    v_dot2_f32_bf16 v43, v23, v7, v43
    v_dot2_f32_bf16 v44, v27, v7, v44
    v_dot2_f32_bf16 v45, v31, v7, v45
    v_dot2_f32_bf16 v46, v35, v7, v46
    v_dot2_f32_bf16 v47, v39, v7, v47
    s_nop 2
    v_add_f32_dpp v40, v40, v40 row_shr:1 row_mask:0xf bank_mask:0xf bound_ctrl:0
    v_add_f32_dpp v41, v41, v41 row_shr:1 row_mask:0xf bank_mask:0xf bound_ctrl:0
    v_add_f32_dpp v42, v42, v42 row_shr:1 row_mask:0xf bank_mask:0xf bound_ctrl:0
    v_add_f32_dpp v43, v43, v43 row_shr:1 row_mask:0xf bank_mask:0xf bound_ctrl:0
    v_add_f32_dpp v44, v44, v44 row_shr:1 row_mask:0xf bank_mask:0xf bound_ctrl:0
    v_add_f32_dpp v45, v45, v45 row_shr:1 row_mask:0xf bank_mask:0xf bound_ctrl:0
    v_add_f32_dpp v46, v46, v46 row_shr:1 row_mask:0xf bank_mask:0xf bound_ctrl:0
    v_add_f32_dpp v47, v47, v47 row_shr:1 row_mask:0xf bank_mask:0xf bound_ctrl:0
    v_add_f32_dpp v40, v40, v40 row_shr:2 row_mask:0xf bank_mask:0xf bound_ctrl:0
    v_add_f32_dpp v41, v41, v41 row_shr:2 row_mask:0xf bank_mask:0xf bound_ctrl:0
    v_add_f32_dpp v42, v42, v42 row_shr:2 row_mask:0xf bank_mask:0xf bound_ctrl:0
    v_add_f32_dpp v43, v43, v43 row_shr:2 row_mask:0xf bank_mask:0xf bound_ctrl:0
    v_add_f32_dpp v44, v44, v44 row_shr:2 row_mask:0xf bank_mask:0xf bound_ctrl:0
    v_add_f32_dpp v45, v45, v45 row_shr:2 row_mask:0xf bank_mask:0xf bound_ctrl:0
    v_add_f32_dpp v46, v46, v46 row_shr:2 row_mask:0xf bank_mask:0xf bound_ctrl:0
    v_add_f32_dpp v47, v47, v47 row_shr:2 row_mask:0xf bank_mask:0xf bound_ctrl:0
    v_add_f32_dpp v40, v40, v40 row_shr:4 row_mask:0xf bank_mask:0xf bound_ctrl:0
    v_add_f32_dpp v41, v41, v41 row_shr:4 row_mask:0xf bank_mask:0xf bound_ctrl:0
    v_add_f32_dpp v42, v42, v42 row_shr:4 row_mask:0xf bank_mask:0xf bound_ctrl:0
    v_add_f32_dpp v43, v43, v43 row_shr:4 row_mask:0xf bank_mask:0xf bound_ctrl:0
    v_add_f32_dpp v44, v44, v44 row_shr:4 row_mask:0xf bank_mask:0xf bound_ctrl:0
    v_add_f32_dpp v45, v45, v45 row_shr:4 row_mask:0xf bank_mask:0xf bound_ctrl:0
    v_add_f32_dpp v46, v46, v46 row_shr:4 row_mask:0xf bank_mask:0xf bound_ctrl:0
    v_add_f32_dpp v47, v47, v47 row_shr:4 row_mask:0xf bank_mask:0xf bound_ctrl:0
    v_add_f32_dpp v40, v40, v40 row_shr:8 row_mask:0xf bank_mask:0xf bound_ctrl:0
    v_add_f32_dpp v41, v41, v41 row_shr:8 row_mask:0xf bank_mask:0xf bound_ctrl:0
    v_add_f32_dpp v42, v42, v42 row_shr:8 row_mask:0xf bank_mask:0xf bound_ctrl:0
    v_add_f32_dpp v43, v43, v43 row_shr:8 row_mask:0xf bank_mask:0xf bound_ctrl:0
    v_add_f32_dpp v44, v44, v44 row_shr:8 row_mask:0xf bank_mask:0xf bound_ctrl:0
    v_add_f32_dpp v45, v45, v45 row_shr:8 row_mask:0xf bank_mask:0xf bound_ctrl:0
    v_add_f32_dpp v46, v46, v46 row_shr:8 row_mask:0xf bank_mask:0xf bound_ctrl:0
    v_add_f32_dpp v47, v47, v47 row_shr:8 row_mask:0xf bank_mask:0xf bound_ctrl:0
    v_add_f32_dpp v40, v40, v40 row_bcast:15 row_mask:0xa bank_mask:0xf
    v_add_f32_dpp v41, v41, v41 row_bcast:15 row_mask:0xa bank_mask:0xf
    v_add_f32_dpp v42, v42, v42 row_bcast:15 row_mask:0xa bank_mask:0xf
    v_add_f32_dpp v43, v43, v43 row_bcast:15 row_mask:0xa bank_mask:0xf
    v_add_f32_dpp v44, v44, v44 row_bcast:15 row_mask:0xa bank_mask:0xf
    v_add_f32_dpp v45, v45, v45 row_bcast:15 row_mask:0xa bank_mask:0xf
    v_add_f32_dpp v46, v46, v46 row_bcast:15 row_mask:0xa bank_mask:0xf
    v_add_f32_dpp v47, v47, v47 row_bcast:15 row_mask:0xa bank_mask:0xf
    v_add_f32_dpp v40, v40, v40 row_bcast:31 row_mask:0xc bank_mask:0xf
    v_add_f32_dpp v41, v41, v41 row_bcast:31 row_mask:0xc bank_mask:0xf
    v_add_f32_dpp v42, v42, v42 row_bcast:31 row_mask:0xc bank_mask:0xf
    v_add_f32_dpp v43, v43, v43 row_bcast:31 row_mask:0xc bank_mask:0xf
    v_add_f32_dpp v44, v44, v44 row_bcast:31 row_mask:0xc bank_mask:0xf
    v_add_f32_dpp v45, v45, v45 row_bcast:31 row_mask:0xc bank_mask:0xf
    v_add_f32_dpp v46, v46, v46 row_bcast:31 row_mask:0xc bank_mask:0xf
    v_add_f32_dpp v47, v47, v47 row_bcast:31 row_mask:0xc bank_mask:0xf
    v_readlane_b32 s4, v40, 63
    v_readlane_b32 s5, v41, 63
    v_readlane_b32 s6, v42, 63
    v_readlane_b32 s7, v43, 63
    v_readlane_b32 s8, v44, 63
    v_readlane_b32 s9, v45, 63
    v_readlane_b32 s10, v46, 63
    v_readlane_b32 s11, v47, 63
    v_mov_b32 v48, 0
    v_writelane_b32 v48, s4, 0
    v_writelane_b32 v48, s5, 1
    v_writelane_b32 v48, s6, 2
    v_writelane_b32 v48, s7, 3
    v_writelane_b32 v48, s8, 4
    v_writelane_b32 v48, s9, 5
    v_writelane_b32 v48, s10, 6
    v_writelane_b32 v48, s11, 7
    v_cvt_pk_bf16_f32 v48, v48, v48
    v_and_b32 v48, s46, v48
    v_mul_f32 v48, 0xbfb8aa3b, v48
    v_exp_f32 v48, v48
    s_nop 0
    v_add_f32 v48, 1.0, v48
    v_rcp_f32 v48, v48
    s_nop 0
    v_cvt_pk_bf16_f32 v48, v48, v48
    v_mov_b32 v50, 0
    s_nop 1
    v_mov_b32_dpp v50, v48 row_shl:1 row_mask:0xf bank_mask:0xf bound_ctrl:0
    v_perm_b32 v50, v50, v48, s70
    v_mov_b32 v51, s72
    s_lshl_b32 s57, s57, 5
    s_add_u32 s57, s57, 7340032
    v_lshl_add_u32 v2, v1, 2, s57
    s_mov_b64 exec, 0x55
    global_store_dwordx2 v2, v[50:51], s[40:41] sc1
    s_mov_b64 exec, -1
F_exit:
    s_endpgm
F_static:
    s_waitcnt lgkmcnt(3)
    global_store_dwordx4 v11, v[12:15], s[6:7] sc1
    s_waitcnt lgkmcnt(2)
    global_store_dwordx4 v11, v[32:35], s[8:9] sc1
    s_waitcnt lgkmcnt(1)
    global_store_dwordx4 v11, v[36:39], s[10:11] sc1
    s_waitcnt lgkmcnt(0)
    global_store_dwordx4 v11, v[40:43], s[12:13] sc1
    s_waitcnt vmcnt(0)
    v_mov_b32 v3, 163492
    v_mov_b32 v4, 1
    s_mov_b64 exec, 1
    ds_add_rtn_u32 v4, v3, v4
    s_lshl_b32 s47, s43, 3
    s_add_u32 s47, s47, s42
    s_lshl_b32 s47, s47, 7
    s_add_u32 s47, s47, 8388608
    v_mov_b32 v3, s47
    s_waitcnt lgkmcnt(0)
    v_readfirstlane_b32 s56, v4
    v_mov_b32 v4, s72
    s_cmp_lg_u32 s56, 3
    s_cbranch_scc1 L_nosig_t
    global_store_dword v3, v4, s[40:41] sc1
L_nosig_t:
    s_mov_b64 exec, -1
    ds_write_b128 v6, v[64:67] offset:33280
    v_alignbit_b32 v44, v65, v64, 16
    v_alignbit_b32 v45, v66, v65, 16
    v_alignbit_b32 v46, v67, v66, 16
    v_alignbit_b32 v47, v68, v67, 16
    ds_write_b128 v6, v[44:47] offset:37440
    v_pk_mov_b32 v[48:49], v[64:65], v[66:67] op_sel:[1,0]
    v_pk_mov_b32 v[50:51], v[66:67], v[68:69] op_sel:[1,0]
    ds_write_b128 v6, v[48:51] offset:41600
    v_pk_mov_b32 v[52:53], v[44:45], v[46:47] op_sel:[1,0]
    v_mov_b32 v54, v47
    v_alignbit_b32 v55, v69, v68, 16
    ds_write_b128 v6, v[52:55] offset:45760
    ds_write_b128 v6, v[72:75] offset:49920
    v_alignbit_b32 v44, v73, v72, 16
    v_alignbit_b32 v45, v74, v73, 16
    v_alignbit_b32 v46, v75, v74, 16
    v_alignbit_b32 v47, v76, v75, 16
    ds_write_b128 v6, v[44:47] offset:54080
    v_pk_mov_b32 v[48:49], v[72:73], v[74:75] op_sel:[1,0]
    v_pk_mov_b32 v[50:51], v[74:75], v[76:77] op_sel:[1,0]
    ds_write_b128 v6, v[48:51] offset:58240
    v_pk_mov_b32 v[52:53], v[44:45], v[46:47] op_sel:[1,0]
    v_mov_b32 v54, v47
    v_alignbit_b32 v55, v77, v76, 16
    ds_write_b128 v6, v[52:55] offset:62400
    s_and_b32 s47, s44, 3
    s_cmp_lg_u32 s47, 3
    s_cbranch_scc1 L_notail_bs
    s_mov_b32 exec_lo, 0
    s_mov_b32 exec_hi, 0x80000000
    ds_write_b128 v6, v[68:71] offset:33296
    v_alignbit_b32 v44, v69, v68, 16
    v_alignbit_b32 v45, v70, v69, 16
    v_alignbit_b32 v46, v71, v70, 16
    v_alignbit_b32 v47, v71, v71, 16
    ds_write_b128 v6, v[44:47] offset:37456
    v_pk_mov_b32 v[48:49], v[68:69], v[70:71] op_sel:[1,0]
    v_pk_mov_b32 v[50:51], v[70:71], v[70:71] op_sel:[1,0]
    ds_write_b128 v6, v[48:51] offset:41616
    v_pk_mov_b32 v[52:53], v[44:45], v[46:47] op_sel:[1,0]
    v_mov_b32 v54, v47
    ds_write_b128 v6, v[52:55] offset:45776
    ds_write_b128 v6, v[76:79] offset:49936
    v_alignbit_b32 v44, v77, v76, 16
    v_alignbit_b32 v45, v78, v77, 16
    v_alignbit_b32 v46, v79, v78, 16
    v_alignbit_b32 v47, v79, v79, 16
    ds_write_b128 v6, v[44:47] offset:54096
    v_pk_mov_b32 v[48:49], v[76:77], v[78:79] op_sel:[1,0]
    v_pk_mov_b32 v[50:51], v[78:79], v[78:79] op_sel:[1,0]
    ds_write_b128 v6, v[48:51] offset:58256
    v_pk_mov_b32 v[52:53], v[44:45], v[46:47] op_sel:[1,0]
    v_mov_b32 v54, v47
    ds_write_b128 v6, v[52:55] offset:62416
    s_mov_b64 exec, -1
L_notail_bs:
    s_cmp_lg_u32 s47, 0
    s_cbranch_scc1 L_nohead_bs
    s_mov_b64 exec, 1
    v_mov_b32 v44, 0
    v_mov_b32 v45, 0
    v_mov_b32 v46, 0
    v_mov_b32 v47, 0
    v_subrev_u32 v48, 16, v6
    ds_write_b128 v48, v[44:47] offset:33280
    ds_write_b128 v48, v[44:47] offset:37440
    ds_write_b128 v48, v[44:47] offset:41600
    ds_write_b128 v48, v[44:47] offset:45760
    ds_write_b128 v48, v[44:47] offset:49920
    ds_write_b128 v48, v[44:47] offset:54080
    ds_write_b128 v48, v[44:47] offset:58240
    ds_write_b128 v48, v[44:47] offset:62400
    s_mov_b64 exec, -1
L_nohead_bs:
    s_nop 1
    v_and_b32 v3, 31, v1
    v_lshlrev_b32 v3, 10, v3
    s_lshl_b32 s47, s42, 7
    s_add_u32 s47, s47, 8388608
    v_add_u32 v3, s47, v3
    global_load_dword v4, v3, s[40:41] sc1
    s_mov_b32 s73, 0
L_poll_t:
    s_waitcnt vmcnt(0)
    v_cmp_ne_u32 vcc, s72, v4
    s_cbranch_vccz L_polled_t
    global_load_dword v4, v3, s[40:41] sc1
    s_add_u32 s73, s73, 1
    s_cmp_lt_u32 s73, 65536
    s_cbranch_scc1 L_poll_t
    s_waitcnt vmcnt(0)
L_polled_t:
    s_waitcnt vmcnt(0) lgkmcnt(0)
    s_branch F_stage
CODE_END:
.section .rodata,"a"
.p2align 6
.amdhsa_kernel gated_mix__ssm_conv_s4__ssm_conv_h3__prompt_kernel
  .amdhsa_next_free_vgpr 168
  .amdhsa_next_free_sgpr 102
  .amdhsa_accum_offset 168
  .amdhsa_group_segment_fixed_size 0
  .amdhsa_kernarg_size 152
  .amdhsa_user_sgpr_count 2
  .amdhsa_user_sgpr_kernarg_segment_ptr 1
  .amdhsa_system_sgpr_workgroup_id_x 1
  .amdhsa_float_denorm_mode_32 3
.end_amdhsa_kernel
```
